```python
import torch

def _softmax(x, axis=-1):
    return torch.softmax(x, dim=axis)
def _gelu(x):
    return torch.nn.functional.gelu(x, approximate="tanh")
def _silu(x):
    return torch.nn.functional.silu(x)
def _sigmoid(x):
    return torch.sigmoid(x)
def _layernorm(x, axis=-1, eps=1e-5):
    m = x.mean(dim=axis, keepdim=True)
    v = x.var(dim=axis, keepdim=True, unbiased=False)
    return (x - m) / torch.sqrt(v + eps)
def _scatter_add(tgt, idx, src, axis=0):
    return tgt.clone().index_add_(axis, idx, src)
def _segment_sum(src, seg, n):
    out = torch.zeros((n,) + src.shape[1:], dtype=src.dtype)
    return out.index_add_(0, seg, src)
def _pad(x, pw):
    flat = tuple(v for pair in reversed(pw) for v in pair)
    return torch.nn.functional.pad(x, flat)

kernel_name = 'parallel_sum__mha_block_cached__geglu_ffn__decode'

def setup_inputs():

    _w = (lambda a: (lambda t: t.to(torch.bfloat16) if t.is_floating_point() else t)(torch.as_tensor(a)))
    def _A_setup():
        B, Sq, D = 1, 1, 512
        H, Sk, Dh = 32, 32768, 128
        return {
            "x": _w((lambda *s: torch.randn(*s, dtype=torch.bfloat16) * 0.05)(B, Sq, D)),
            "k_cache": _w((lambda *s: torch.randn(*s, dtype=torch.bfloat16) * 3.2)(B, H, Sk, Dh)),
            "v_cache": _w((lambda *s: torch.randn(*s, dtype=torch.bfloat16) * 1.6)(B, H, Sk, Dh)),
            "wq": _w((lambda *s: torch.randn(*s, dtype=torch.bfloat16) * 3.2)(D, H * Dh) * (D ** -0.5)),
            "wo": _w((lambda *s: torch.randn(*s, dtype=torch.bfloat16) * 1.6)(H * Dh, D) * ((H * Dh) ** -0.5)),
        }
    _A_in = _A_setup()

    def _B_setup():
        B, S, D, F = 1, 1, 512, 1376
        return {
            "x": _w((lambda *s: torch.randn(*s, dtype=torch.bfloat16) * 0.05)(B, S, D)),
            "w_gate": _w((lambda *s: torch.randn(*s, dtype=torch.bfloat16) * 0.05)(D, F)),
            "w_up": _w((lambda *s: torch.randn(*s, dtype=torch.bfloat16) * 0.05)(D, F)),
            "w_down": _w((lambda *s: torch.randn(*s, dtype=torch.bfloat16) * 0.05)(F, D)),
        }
    _B_in = _B_setup()

    return {
        "A_x": _A_in["x"],
        "A_k_cache": _A_in["k_cache"],
        "A_v_cache": _A_in["v_cache"],
        "A_wq": _A_in["wq"],
        "A_wo": _A_in["wo"],
        "B_x": _B_in["x"],
        "B_w_gate": _B_in["w_gate"],
        "B_w_up": _B_in["w_up"],
        "B_w_down": _B_in["w_down"],
    }

def reference(A_x, A_k_cache, A_v_cache, A_wq, A_wo, B_x, B_w_gate, B_w_up, B_w_down):
    def _A_ref(x, k_cache, v_cache, wq, wo):
        B, Sq, D = x.shape
        H, Dh = 32, 128
        q = (lambda x, *d: x.permute(*d))((x @ wq).reshape(B, Sq, H, Dh), 0, 2, 1, 3)
        scores = torch.einsum("bhqd,bhkd->bhqk", q, k_cache) * (Dh ** -0.5)
        p = _softmax(scores, axis=-1)
        o = torch.einsum("bhqk,bhkd->bhqd", p, v_cache)
        return (lambda x, *d: x.permute(*d))(o, 0, 2, 1, 3).reshape(B, Sq, H * Dh) @ wo

    def _B_ref(x, w_gate, w_up, w_down):
        return (_gelu(x @ w_gate) * (x @ w_up)) @ w_down

    x = A_x
    xn = _layernorm(x, axis=-1)
    return x + _A_ref(xn, A_k_cache, A_v_cache, A_wq, A_wo) + _B_ref(xn, B_w_gate, B_w_up, B_w_down)
```

```asm
; @launch grid=(256,1,1) block=(512,1,1) lds=21504
.amdgcn_target "amdgcn-amd-amdhsa--gfx950"
.text
.globl parallel_sum__mha_block_cached__geglu_ffn__decode_kernel
.p2align 8
.type parallel_sum__mha_block_cached__geglu_ffn__decode_kernel,@function
parallel_sum__mha_block_cached__geglu_ffn__decode_kernel:
  s_cmp_ge_u32 s2, 256
  s_cbranch_scc1 L_end
  s_setprio 3
  s_load_dwordx16 s[16:31], s[0:1], 0
  s_load_dwordx8 s[32:39], s[0:1], 64
  s_memrealtime s[82:83]
  v_lshrrev_b32 v3, 6, v0
  v_and_b32 v2, 63, v0
  v_readfirstlane_b32 s54, v3
  v_lshlrev_b32 v1, 4, v2
  s_and_b32 s52, s2, 31
  s_lshr_b32 s53, s2, 5
  s_and_b32 s77, s2, 3
  s_mov_b32 s59, 0xffff0000
  v_lshrrev_b32 v3, 4, v0
  v_lshlrev_b32 v3, 17, v3
  v_and_b32 v11, 15, v0
  v_lshl_add_u32 v200, v11, 4, v3
  v_mov_b32 v241, 0
  s_cmp_lg_u32 s54, 0
  s_cbranch_scc1 L_noinit
  v_mov_b32 v24, 0
  v_mov_b32 v25, 0
  v_mov_b32 v26, 0
  v_mov_b32 v27, 0
  ds_write_b128 v241, v[24:27] offset:4096
  v_mov_b32 v24, 16
  ds_write_b32 v241, v24 offset:4112
L_noinit:
  s_waitcnt lgkmcnt(0)
  s_barrier
  s_lshr_b64 s[82:83], s[82:83], 11
  s_mov_b32 s69, s82
  s_sub_u32 s81, s82, 1
  global_load_dwordx4 v[32:35], v1, s[16:17]
  s_mov_b32 s84, s22
  s_mov_b32 s85, s23
  s_mov_b32 s86, 0x400000
  s_mov_b32 s87, 0x20000
  s_lshl_b32 s64, s52, 8
  buffer_load_dwordx4 v[128:131], v200, s[84:87], s64 offen
  s_add_u32 s64, s64, 8192
  buffer_load_dwordx4 v[132:135], v200, s[84:87], s64 offen
  s_add_u32 s64, s64, 8192
  buffer_load_dwordx4 v[136:139], v200, s[84:87], s64 offen
  s_add_u32 s64, s64, 8192
  buffer_load_dwordx4 v[140:143], v200, s[84:87], s64 offen
  s_add_u32 s64, s64, 8192
  buffer_load_dwordx4 v[144:147], v200, s[84:87], s64 offen
  s_add_u32 s64, s64, 8192
  buffer_load_dwordx4 v[148:151], v200, s[84:87], s64 offen
  s_add_u32 s64, s64, 8192
  buffer_load_dwordx4 v[152:155], v200, s[84:87], s64 offen
  s_add_u32 s64, s64, 8192
  buffer_load_dwordx4 v[156:159], v200, s[84:87], s64 offen
  s_add_u32 s64, s64, 8192
  buffer_load_dwordx4 v[160:163], v200, s[84:87], s64 offen
  s_add_u32 s64, s64, 8192
  buffer_load_dwordx4 v[164:167], v200, s[84:87], s64 offen
  s_add_u32 s64, s64, 8192
  buffer_load_dwordx4 v[168:171], v200, s[84:87], s64 offen
  s_add_u32 s64, s64, 8192
  buffer_load_dwordx4 v[172:175], v200, s[84:87], s64 offen
  s_add_u32 s64, s64, 8192
  buffer_load_dwordx4 v[176:179], v200, s[84:87], s64 offen
  s_add_u32 s64, s64, 8192
  buffer_load_dwordx4 v[180:183], v200, s[84:87], s64 offen
  s_add_u32 s64, s64, 8192
  buffer_load_dwordx4 v[184:187], v200, s[84:87], s64 offen
  s_add_u32 s64, s64, 8192
  buffer_load_dwordx4 v[188:191], v200, s[84:87], s64 offen
  s_lshr_b32 s62, s2, 2
  s_and_b32 s63, s62, 1
  s_lshr_b32 s62, s62, 1
  s_lshr_b32 s55, s62, 1
  s_lshl_b32 s55, s55, 2
  s_lshl_b32 s63, s63, 1
  s_add_u32 s55, s55, s63
  s_and_b32 s62, s62, 1
  s_add_u32 s55, s55, s62
  s_cmp_lt_u32 s55, 43
  s_cselect_b32 s56, 1, 0
  s_cselect_b32 s55, s55, 0
  v_lshrrev_b32 v201, 2, v0
  s_lshl_b32 s64, s77, 7
  v_add_u32 v201, s64, v201
  s_movk_i32 s64, 2752
  v_mul_u32_u24 v201, s64, v201
  v_and_b32 v24, 3, v0
  v_lshl_add_u32 v201, v24, 4, v201
  s_lshl_b32 s65, s55, 6
  v_add_u32 v201, s65, v201
  global_load_dwordx4 v[56:59], v201, s[28:29]
  global_load_dwordx4 v[60:63], v201, s[30:31]
  s_mov_b32 s60, 0x3db504f3
  s_mov_b32 s61, 0x3fb8aa3b
  s_lshl_b32 s64, s52, 23
  s_add_u32 s40, s18, s64
  s_addc_u32 s41, s19, 0
  s_mov_b32 s42, 0x800000
  s_mov_b32 s43, 0x20000
  s_add_u32 s44, s20, s64
  s_addc_u32 s45, s21, 0
  s_mov_b32 s46, 0x800000
  s_mov_b32 s47, 0x20000
  s_lshl_b32 s64, s53, 3
  s_add_u32 s64, s64, s54
  s_lshl_b32 s57, s53, 20
  s_lshl_b32 s65, s54, 12
  s_add_u32 s57, s57, s65
  s_add_u32 s64, s54, 8
  v_mov_b32 v240, s64
  v_mov_b32 v242, 1
  v_and_b32 v4, 15, v2
  v_lshrrev_b32 v5, 4, v2
  v_lshlrev_b32 v24, 4, v4
  v_lshlrev_b32 v4, 8, v4
  v_lshl_add_u32 v4, v5, 4, v4
  v_lshl_add_u32 v5, v5, 10, v24
  s_mov_b32 s6, 0x05040100
  s_mov_b32 s7, 0x07060302
  s_waitcnt vmcnt(18)
  v_lshlrev_b32 v12, 16, v32
  v_and_b32 v13, s59, v32
  v_lshlrev_b32 v14, 16, v33
  v_and_b32 v15, s59, v33
  v_lshlrev_b32 v16, 16, v34
  v_and_b32 v17, s59, v34
  v_lshlrev_b32 v18, 16, v35
  v_and_b32 v19, s59, v35
  v_add_f32 v20, v12, v13
  v_add_f32 v3, v14, v15
  v_add_f32 v11, v16, v17
  v_add_f32 v23, v18, v19
  v_add_f32 v20, v20, v3
  v_add_f32 v11, v11, v23
  v_add_f32 v20, v20, v11
  s_nop 1
  v_add_f32_dpp v20, v20, v20 quad_perm:[1,0,3,2] row_mask:0xf bank_mask:0xf
  s_nop 1
  v_add_f32_dpp v20, v20, v20 quad_perm:[2,3,0,1] row_mask:0xf bank_mask:0xf
  s_nop 1
  v_add_f32_dpp v20, v20, v20 row_half_mirror row_mask:0xf bank_mask:0xf
  s_nop 1
  v_add_f32_dpp v20, v20, v20 row_mirror row_mask:0xf bank_mask:0xf
  s_nop 1
  s_nop 0
  v_readlane_b32 s62, v20, 0
  v_readlane_b32 s63, v20, 16
  v_readlane_b32 s64, v20, 32
  v_readlane_b32 s65, v20, 48
  s_nop 1
  v_mov_b32 v20, s62
  v_add_f32 v20, s63, v20
  v_add_f32 v20, s64, v20
  v_add_f32 v20, s65, v20
  v_mul_f32 v21, 0x3b000000, v20
  v_sub_f32 v12, v12, v21
  v_sub_f32 v13, v13, v21
  v_sub_f32 v14, v14, v21
  v_sub_f32 v15, v15, v21
  v_sub_f32 v16, v16, v21
  v_sub_f32 v17, v17, v21
  v_sub_f32 v18, v18, v21
  v_sub_f32 v19, v19, v21
  v_mul_f32 v22, v12, v12
  v_mul_f32 v3, v13, v13
  v_fmac_f32 v22, v14, v14
  v_fmac_f32 v3, v15, v15
  v_fmac_f32 v22, v16, v16
  v_fmac_f32 v3, v17, v17
  v_fmac_f32 v22, v18, v18
  v_fmac_f32 v3, v19, v19
  v_add_f32 v22, v22, v3
  s_nop 1
  v_add_f32_dpp v22, v22, v22 quad_perm:[1,0,3,2] row_mask:0xf bank_mask:0xf
  s_nop 1
  v_add_f32_dpp v22, v22, v22 quad_perm:[2,3,0,1] row_mask:0xf bank_mask:0xf
  s_nop 1
  v_add_f32_dpp v22, v22, v22 row_half_mirror row_mask:0xf bank_mask:0xf
  s_nop 1
  v_add_f32_dpp v22, v22, v22 row_mirror row_mask:0xf bank_mask:0xf
  s_nop 1
  s_nop 0
  v_readlane_b32 s62, v22, 0
  v_readlane_b32 s63, v22, 16
  v_readlane_b32 s64, v22, 32
  v_readlane_b32 s65, v22, 48
  s_nop 1
  v_mov_b32 v22, s62
  v_add_f32 v22, s63, v22
  v_add_f32 v22, s64, v22
  v_add_f32 v22, s65, v22
  v_mul_f32 v22, 0x3b000000, v22
  v_cvt_pk_bf16_f32 v3, v21, v22
  v_lshlrev_b32 v21, 16, v3
  v_and_b32 v22, s59, v3
  v_add_f32 v22, 0x3727c5ac, v22
  v_cvt_pk_bf16_f32 v3, v22, v22
  v_lshlrev_b32 v22, 16, v3
  v_sqrt_f32 v22, v22
  v_lshlrev_b32 v12, 16, v32
  v_and_b32 v13, s59, v32
  v_lshlrev_b32 v14, 16, v33
  v_and_b32 v15, s59, v33
  v_lshlrev_b32 v16, 16, v34
  v_and_b32 v17, s59, v34
  v_lshlrev_b32 v18, 16, v35
  v_and_b32 v19, s59, v35
  v_cvt_pk_bf16_f32 v3, v22, v22
  v_lshlrev_b32 v22, 16, v3
  v_rcp_f32 v23, v22
  v_sub_f32 v12, v12, v21
  v_sub_f32 v13, v13, v21
  v_sub_f32 v14, v14, v21
  v_sub_f32 v15, v15, v21
  v_sub_f32 v16, v16, v21
  v_sub_f32 v17, v17, v21
  v_sub_f32 v18, v18, v21
  v_sub_f32 v19, v19, v21
  v_cvt_pk_bf16_f32 v3, v12, v13
  v_lshlrev_b32 v12, 16, v3
  v_and_b32 v13, s59, v3
  v_cvt_pk_bf16_f32 v3, v14, v15
  v_lshlrev_b32 v14, 16, v3
  v_and_b32 v15, s59, v3
  v_cvt_pk_bf16_f32 v3, v16, v17
  v_lshlrev_b32 v16, 16, v3
  v_and_b32 v17, s59, v3
  v_cvt_pk_bf16_f32 v3, v18, v19
  v_lshlrev_b32 v18, 16, v3
  v_and_b32 v19, s59, v3
  v_mul_f32 v208, v12, v23
  v_mul_f32 v209, v13, v23
  v_mul_f32 v210, v14, v23
  v_mul_f32 v211, v15, v23
  v_mul_f32 v212, v16, v23
  v_mul_f32 v213, v17, v23
  v_mul_f32 v214, v18, v23
  v_mul_f32 v215, v19, v23
  v_fma_f32 v216, -v208, v22, v12
  v_fma_f32 v217, -v209, v22, v13
  v_fma_f32 v218, -v210, v22, v14
  v_fma_f32 v219, -v211, v22, v15
  v_fma_f32 v220, -v212, v22, v16
  v_fma_f32 v221, -v213, v22, v17
  v_fma_f32 v222, -v214, v22, v18
  v_fma_f32 v223, -v215, v22, v19
  v_fma_f32 v12, v216, v23, v208
  v_fma_f32 v13, v217, v23, v209
  v_fma_f32 v14, v218, v23, v210
  v_fma_f32 v15, v219, v23, v211
  v_fma_f32 v16, v220, v23, v212
  v_fma_f32 v17, v221, v23, v213
  v_fma_f32 v18, v222, v23, v214
  v_fma_f32 v19, v223, v23, v215
  v_cvt_pk_bf16_f32 v208, v12, v13
  v_cvt_pk_bf16_f32 v209, v14, v15
  v_cvt_pk_bf16_f32 v210, v16, v17
  v_cvt_pk_bf16_f32 v211, v18, v19
  ds_write_b128 v1, v[208:211] offset:5120
  v_lshrrev_b32 v3, 4, v0
  v_lshlrev_b32 v3, 5, v3
  v_lshrrev_b32 v11, 2, v0
  s_lshl_b32 s64, s77, 8
  v_lshl_add_u32 v11, v11, 1, s64
  s_waitcnt lgkmcnt(0)
  ds_read_b128 v[224:227], v3 offset:5120
  ds_read_b128 v[228:231], v3 offset:5136
  ds_read_u16 v246, v11 offset:5120
  v_mov_b32 v12, 0
  v_mov_b32 v13, 0
  v_mov_b32 v14, 0
  v_mov_b32 v15, 0
  v_mov_b32 v16, 0
  v_mov_b32 v17, 0
  v_mov_b32 v18, 0
  v_mov_b32 v19, 0
  s_waitcnt lgkmcnt(0)
  v_lshlrev_b32 v246, 16, v246
  s_waitcnt vmcnt(16)
  v_perm_b32 v24, v132, v128, s6
  v_perm_b32 v25, v132, v128, s7
  v_perm_b32 v26, v133, v129, s6
  v_perm_b32 v27, v133, v129, s7
  v_perm_b32 v28, v134, v130, s6
  v_perm_b32 v29, v134, v130, s7
  v_perm_b32 v30, v135, v131, s6
  v_perm_b32 v31, v135, v131, s7
  v_dot2_f32_bf16 v12, v24, v224, v12
  v_dot2_f32_bf16 v13, v25, v224, v13
  v_dot2_f32_bf16 v14, v26, v224, v14
  v_dot2_f32_bf16 v15, v27, v224, v15
  v_dot2_f32_bf16 v16, v28, v224, v16
  v_dot2_f32_bf16 v17, v29, v224, v17
  v_dot2_f32_bf16 v18, v30, v224, v18
  v_dot2_f32_bf16 v19, v31, v224, v19
  s_waitcnt vmcnt(14)
  v_perm_b32 v24, v140, v136, s6
  v_perm_b32 v25, v140, v136, s7
  v_perm_b32 v26, v141, v137, s6
  v_perm_b32 v27, v141, v137, s7
  v_perm_b32 v28, v142, v138, s6
  v_perm_b32 v29, v142, v138, s7
  v_perm_b32 v30, v143, v139, s6
  v_perm_b32 v31, v143, v139, s7
  v_dot2_f32_bf16 v12, v24, v225, v12
  v_dot2_f32_bf16 v13, v25, v225, v13
  v_dot2_f32_bf16 v14, v26, v225, v14
  v_dot2_f32_bf16 v15, v27, v225, v15
  v_dot2_f32_bf16 v16, v28, v225, v16
  v_dot2_f32_bf16 v17, v29, v225, v17
  v_dot2_f32_bf16 v18, v30, v225, v18
  v_dot2_f32_bf16 v19, v31, v225, v19
  s_waitcnt vmcnt(12)
  v_perm_b32 v24, v148, v144, s6
  v_perm_b32 v25, v148, v144, s7
  v_perm_b32 v26, v149, v145, s6
  v_perm_b32 v27, v149, v145, s7
  v_perm_b32 v28, v150, v146, s6
  v_perm_b32 v29, v150, v146, s7
  v_perm_b32 v30, v151, v147, s6
  v_perm_b32 v31, v151, v147, s7
  v_dot2_f32_bf16 v12, v24, v226, v12
  v_dot2_f32_bf16 v13, v25, v226, v13
  v_dot2_f32_bf16 v14, v26, v226, v14
  v_dot2_f32_bf16 v15, v27, v226, v15
  v_dot2_f32_bf16 v16, v28, v226, v16
  v_dot2_f32_bf16 v17, v29, v226, v17
  v_dot2_f32_bf16 v18, v30, v226, v18
  v_dot2_f32_bf16 v19, v31, v226, v19
  s_waitcnt vmcnt(10)
  v_perm_b32 v24, v156, v152, s6
  v_perm_b32 v25, v156, v152, s7
  v_perm_b32 v26, v157, v153, s6
  v_perm_b32 v27, v157, v153, s7
  v_perm_b32 v28, v158, v154, s6
  v_perm_b32 v29, v158, v154, s7
  v_perm_b32 v30, v159, v155, s6
  v_perm_b32 v31, v159, v155, s7
  v_dot2_f32_bf16 v12, v24, v227, v12
  v_dot2_f32_bf16 v13, v25, v227, v13
  v_dot2_f32_bf16 v14, v26, v227, v14
  v_dot2_f32_bf16 v15, v27, v227, v15
  v_dot2_f32_bf16 v16, v28, v227, v16
  v_dot2_f32_bf16 v17, v29, v227, v17
  v_dot2_f32_bf16 v18, v30, v227, v18
  v_dot2_f32_bf16 v19, v31, v227, v19
  s_waitcnt vmcnt(8)
  v_perm_b32 v24, v164, v160, s6
  v_perm_b32 v25, v164, v160, s7
  v_perm_b32 v26, v165, v161, s6
  v_perm_b32 v27, v165, v161, s7
  v_perm_b32 v28, v166, v162, s6
  v_perm_b32 v29, v166, v162, s7
  v_perm_b32 v30, v167, v163, s6
  v_perm_b32 v31, v167, v163, s7
  v_dot2_f32_bf16 v12, v24, v228, v12
  v_dot2_f32_bf16 v13, v25, v228, v13
  v_dot2_f32_bf16 v14, v26, v228, v14
  v_dot2_f32_bf16 v15, v27, v228, v15
  v_dot2_f32_bf16 v16, v28, v228, v16
  v_dot2_f32_bf16 v17, v29, v228, v17
  v_dot2_f32_bf16 v18, v30, v228, v18
  v_dot2_f32_bf16 v19, v31, v228, v19
  s_waitcnt vmcnt(6)
  v_perm_b32 v24, v172, v168, s6
  v_perm_b32 v25, v172, v168, s7
  v_perm_b32 v26, v173, v169, s6
  v_perm_b32 v27, v173, v169, s7
  v_perm_b32 v28, v174, v170, s6
  v_perm_b32 v29, v174, v170, s7
  v_perm_b32 v30, v175, v171, s6
  v_perm_b32 v31, v175, v171, s7
  v_dot2_f32_bf16 v12, v24, v229, v12
  v_dot2_f32_bf16 v13, v25, v229, v13
  v_dot2_f32_bf16 v14, v26, v229, v14
  v_dot2_f32_bf16 v15, v27, v229, v15
  v_dot2_f32_bf16 v16, v28, v229, v16
  v_dot2_f32_bf16 v17, v29, v229, v17
  v_dot2_f32_bf16 v18, v30, v229, v18
  v_dot2_f32_bf16 v19, v31, v229, v19
  s_waitcnt vmcnt(4)
  v_perm_b32 v24, v180, v176, s6
  v_perm_b32 v25, v180, v176, s7
  v_perm_b32 v26, v181, v177, s6
  v_perm_b32 v27, v181, v177, s7
  v_perm_b32 v28, v182, v178, s6
  v_perm_b32 v29, v182, v178, s7
  v_perm_b32 v30, v183, v179, s6
  v_perm_b32 v31, v183, v179, s7
  v_dot2_f32_bf16 v12, v24, v230, v12
  v_dot2_f32_bf16 v13, v25, v230, v13
  v_dot2_f32_bf16 v14, v26, v230, v14
  v_dot2_f32_bf16 v15, v27, v230, v15
  v_dot2_f32_bf16 v16, v28, v230, v16
  v_dot2_f32_bf16 v17, v29, v230, v17
  v_dot2_f32_bf16 v18, v30, v230, v18
  v_dot2_f32_bf16 v19, v31, v230, v19
  s_waitcnt vmcnt(2)
  v_perm_b32 v24, v188, v184, s6
  v_perm_b32 v25, v188, v184, s7
  v_perm_b32 v26, v189, v185, s6
  v_perm_b32 v27, v189, v185, s7
  v_perm_b32 v28, v190, v186, s6
  v_perm_b32 v29, v190, v186, s7
  v_perm_b32 v30, v191, v187, s6
  v_perm_b32 v31, v191, v187, s7
  v_dot2_f32_bf16 v12, v24, v231, v12
  v_dot2_f32_bf16 v13, v25, v231, v13
  v_dot2_f32_bf16 v14, v26, v231, v14
  v_dot2_f32_bf16 v15, v27, v231, v15
  v_dot2_f32_bf16 v16, v28, v231, v16
  v_dot2_f32_bf16 v17, v29, v231, v17
  v_dot2_f32_bf16 v18, v30, v231, v18
  v_dot2_f32_bf16 v19, v31, v231, v19
  s_nop 1
  s_nop 1
  v_permlane32_swap_b32 v12, v16
  v_permlane32_swap_b32 v13, v17
  v_permlane32_swap_b32 v14, v18
  v_permlane32_swap_b32 v15, v19
  s_nop 0
  v_add_f32 v12, v12, v16
  v_add_f32 v13, v13, v17
  v_add_f32 v14, v14, v18
  v_add_f32 v15, v15, v19
  s_nop 1
  v_permlane16_swap_b32 v12, v14
  v_permlane16_swap_b32 v13, v15
  s_nop 0
  v_add_f32 v12, v12, v14
  v_add_f32 v13, v13, v15
  v_and_b32 v244, 15, v2
  v_lshlrev_b32 v244, 5, v244
  v_lshrrev_b32 v11, 4, v2
  v_lshl_add_u32 v244, v11, 3, v244
  s_lshl_b32 s64, s54, 9
  v_add_u32 v3, s64, v244
  ds_write_b64 v3, v[12:13] offset:0
  s_waitcnt lgkmcnt(0)
  s_mov_b64 exec, 1
  ds_add_u32 v241, v242 offset:4104
  s_mov_b64 exec, -1
  s_setprio 0
  buffer_load_dwordx4 v[64:67], v4, s[40:43], s57 offen offset:0 nt
  buffer_load_dwordx4 v[68:71], v4, s[40:43], s57 offen offset:64 nt
  buffer_load_dwordx4 v[72:75], v4, s[40:43], s57 offen offset:128 nt
  buffer_load_dwordx4 v[76:79], v4, s[40:43], s57 offen offset:192 nt
  buffer_load_dwordx4 v[80:83], v5, s[44:47], s57 offen offset:0 nt
  buffer_load_dwordx4 v[84:87], v5, s[44:47], s57 offen offset:256 nt
  buffer_load_dwordx4 v[88:91], v5, s[44:47], s57 offen offset:512 nt
  buffer_load_dwordx4 v[92:95], v5, s[44:47], s57 offen offset:768 nt
  s_add_u32 s57, s57, 32768
  s_waitcnt vmcnt(8)
  v_lshlrev_b32 v208, 16, v56
  v_and_b32 v209, s59, v56
  v_lshlrev_b32 v210, 16, v57
  v_and_b32 v211, s59, v57
  v_lshlrev_b32 v212, 16, v58
  v_and_b32 v213, s59, v58
  v_lshlrev_b32 v214, 16, v59
  v_and_b32 v215, s59, v59
  v_lshlrev_b32 v216, 16, v60
  v_and_b32 v217, s59, v60
  v_lshlrev_b32 v218, 16, v61
  v_and_b32 v219, s59, v61
  v_lshlrev_b32 v220, 16, v62
  v_and_b32 v221, s59, v62
  v_lshlrev_b32 v222, 16, v63
  v_and_b32 v223, s59, v63
  v_mul_f32 v208, v246, v208
  v_mul_f32 v209, v246, v209
  v_mul_f32 v210, v246, v210
  v_mul_f32 v211, v246, v211
  v_mul_f32 v212, v246, v212
  v_mul_f32 v213, v246, v213
  v_mul_f32 v214, v246, v214
  v_mul_f32 v215, v246, v215
  v_mul_f32 v216, v246, v216
  v_mul_f32 v217, v246, v217
  v_mul_f32 v218, v246, v218
  v_mul_f32 v219, v246, v219
  v_mul_f32 v220, v246, v220
  v_mul_f32 v221, v246, v221
  v_mul_f32 v222, v246, v222
  v_mul_f32 v223, v246, v223
  s_nop 1
  v_permlane32_swap_b32 v208, v216
  v_permlane32_swap_b32 v209, v217
  v_permlane32_swap_b32 v210, v218
  v_permlane32_swap_b32 v211, v219
  v_permlane32_swap_b32 v212, v220
  v_permlane32_swap_b32 v213, v221
  v_permlane32_swap_b32 v214, v222
  v_permlane32_swap_b32 v215, v223
  s_nop 0
  v_add_f32 v208, v208, v216
  v_add_f32 v209, v209, v217
  v_add_f32 v210, v210, v218
  v_add_f32 v211, v211, v219
  v_add_f32 v212, v212, v220
  v_add_f32 v213, v213, v221
  v_add_f32 v214, v214, v222
  v_add_f32 v215, v215, v223
  s_nop 1
  v_permlane16_swap_b32 v208, v212
  v_permlane16_swap_b32 v209, v213
  v_permlane16_swap_b32 v210, v214
  v_permlane16_swap_b32 v211, v215
  s_nop 0
  v_add_f32 v208, v208, v212
  v_add_f32 v209, v209, v213
  v_add_f32 v210, v210, v214
  v_add_f32 v211, v211, v215
  s_nop 1
  v_add_f32_dpp v208, v208, v208 row_ror:4 row_mask:0xf bank_mask:0xf
  v_add_f32_dpp v209, v209, v209 row_ror:4 row_mask:0xf bank_mask:0xf
  v_add_f32_dpp v210, v210, v210 row_ror:4 row_mask:0xf bank_mask:0xf
  v_add_f32_dpp v211, v211, v211 row_ror:4 row_mask:0xf bank_mask:0xf
  v_add_f32_dpp v208, v208, v208 row_ror:8 row_mask:0xf bank_mask:0xf
  v_add_f32_dpp v209, v209, v209 row_ror:8 row_mask:0xf bank_mask:0xf
  v_add_f32_dpp v210, v210, v210 row_ror:8 row_mask:0xf bank_mask:0xf
  v_add_f32_dpp v211, v211, v211 row_ror:8 row_mask:0xf bank_mask:0xf
  v_lshrrev_b32 v3, 5, v2
  v_lshlrev_b32 v3, 7, v3
  v_and_b32 v11, 3, v2
  v_lshl_add_u32 v3, v11, 5, v3
  v_bfe_u32 v11, v2, 4, 1
  v_lshl_add_u32 v3, v11, 4, v3
  s_lshl_b32 s64, s54, 8
  v_add_u32 v3, s64, v3
  ds_write_b128 v3, v[208:211] offset:6144
  s_waitcnt lgkmcnt(0)
  s_mov_b64 exec, 1
  ds_add_u32 v241, v242 offset:4108
  s_mov_b64 exec, -1
  s_cmp_lg_u32 s54, 7
  s_cbranch_scc1 L_nopubf
  s_cmp_eq_u32 s56, 0
  s_cbranch_scc1 L_nopubf
  s_mov_b32 s76, 0
L_spc2:
  ds_read_b32 v24, v241 offset:4108
  s_add_u32 s76, s76, 1
  s_cmp_gt_u32 s76, 2000000
  s_cbranch_scc1 L_spc2_ok
  s_waitcnt lgkmcnt(0)
  v_cmp_eq_u32 vcc, 8, v24
  s_cbranch_vccz L_spc2
L_spc2_ok:
  v_lshlrev_b32 v3, 2, v2
  ds_read_b32 v208, v3 offset:6144
  ds_read_b32 v209, v3 offset:6400
  ds_read_b32 v210, v3 offset:6656
  ds_read_b32 v211, v3 offset:6912
  ds_read_b32 v212, v3 offset:7168
  ds_read_b32 v213, v3 offset:7424
  ds_read_b32 v214, v3 offset:7680
  ds_read_b32 v215, v3 offset:7936
  s_waitcnt lgkmcnt(0)
  v_add_f32 v208, v208, v209
  v_add_f32 v208, v208, v210
  v_add_f32 v208, v208, v211
  v_add_f32 v208, v208, v212
  v_add_f32 v208, v208, v213
  v_add_f32 v208, v208, v214
  v_add_f32 v208, v208, v215
  v_mov_b32 v209, s69
  s_lshl_b32 s64, s55, 11
  s_lshl_b32 s65, s77, 3
  s_add_u32 s64, s64, s65
  s_add_u32 s64, s64, 786432
  v_and_b32 v3, 31, v2
  v_lshlrev_b32 v3, 6, v3
  v_lshrrev_b32 v11, 5, v2
  v_lshl_add_u32 v3, v11, 5, v3
  v_add_u32 v3, s64, v3
  global_store_dwordx2 v3, v[208:209], s[38:39] sc0 sc1
L_nopubf:
  s_lshl_b32 s64, s52, 3
  s_add_u32 s64, s64, s53
  s_lshl_b32 s64, s64, 11
  s_add_u32 s70, s38, s64
  s_addc_u32 s71, s39, 0
  s_lshl_b32 s64, s53, 5
  s_add_u32 s64, s64, s52
  s_lshl_b32 s64, s64, 10
  s_add_u32 s64, s64, 524288
  s_add_u32 s72, s38, s64
  s_addc_u32 s73, s39, 0
  s_lshl_b32 s64, s52, 8
  s_add_u32 s64, s64, 1048576
  s_add_u32 s48, s38, s64
  s_addc_u32 s49, s39, 0
  s_lshl_b32 s64, s52, 12
  s_add_u32 s64, s64, 917504
  s_add_u32 s50, s38, s64
  s_addc_u32 s51, s39, 0
  s_lshl_b32 s64, s53, 7
  s_lshl_b32 s65, s52, 2
  s_add_u32 s64, s64, s65
  s_load_dword s68, s[16:17], s64
  buffer_load_dwordx4 v[96:99], v4, s[40:43], s57 offen offset:0 nt
  buffer_load_dwordx4 v[100:103], v4, s[40:43], s57 offen offset:64 nt
  buffer_load_dwordx4 v[104:107], v4, s[40:43], s57 offen offset:128 nt
  buffer_load_dwordx4 v[108:111], v4, s[40:43], s57 offen offset:192 nt
  buffer_load_dwordx4 v[112:115], v5, s[44:47], s57 offen offset:0 nt
  buffer_load_dwordx4 v[116:119], v5, s[44:47], s57 offen offset:256 nt
  buffer_load_dwordx4 v[120:123], v5, s[44:47], s57 offen offset:512 nt
  buffer_load_dwordx4 v[124:127], v5, s[44:47], s57 offen offset:768 nt
  s_add_u32 s57, s57, 32768
  s_mov_b32 s76, 0
L_spc1:
  ds_read_b32 v24, v241 offset:4104
  s_add_u32 s76, s76, 1
  s_cmp_gt_u32 s76, 2000000
  s_cbranch_scc1 L_spc1_ok
  s_waitcnt lgkmcnt(0)
  v_cmp_eq_u32 vcc, 8, v24
  s_cbranch_vccz L_spc1
L_spc1_ok:
  ds_read_b64 v[208:209], v244 offset:0
  ds_read_b64 v[210:211], v244 offset:512
  ds_read_b64 v[212:213], v244 offset:1024
  ds_read_b64 v[214:215], v244 offset:1536
  ds_read_b64 v[216:217], v244 offset:2048
  ds_read_b64 v[218:219], v244 offset:2560
  ds_read_b64 v[220:221], v244 offset:3072
  ds_read_b64 v[222:223], v244 offset:3584
  s_waitcnt lgkmcnt(0)
  v_add_f32 v208, v208, v210
  v_add_f32 v209, v209, v211
  v_add_f32 v208, v208, v212
  v_add_f32 v209, v209, v213
  v_add_f32 v208, v208, v214
  v_add_f32 v209, v209, v215
  v_add_f32 v208, v208, v216
  v_add_f32 v209, v209, v217
  v_add_f32 v208, v208, v218
  v_add_f32 v209, v209, v219
  v_add_f32 v208, v208, v220
  v_add_f32 v209, v209, v221
  v_add_f32 v208, v208, v222
  v_add_f32 v209, v209, v223
  v_cvt_pk_bf16_f32 v208, v208, v209
  v_lshrrev_b32 v3, 1, v244
  ds_write_b32 v3, v208 offset:4352
  v_lshrrev_b32 v11, 4, v2
  v_lshlrev_b32 v11, 4, v11
  s_waitcnt lgkmcnt(0)
  ds_read_b128 v[208:211], v11 offset:4352
  ds_read_b128 v[212:215], v11 offset:4416
  ds_read_b128 v[216:219], v11 offset:4480
  ds_read_b128 v[220:223], v11 offset:4544
  buffer_load_dwordx4 v[128:131], v4, s[40:43], s57 offen offset:0 nt
  buffer_load_dwordx4 v[132:135], v4, s[40:43], s57 offen offset:64 nt
  buffer_load_dwordx4 v[136:139], v4, s[40:43], s57 offen offset:128 nt
  buffer_load_dwordx4 v[140:143], v4, s[40:43], s57 offen offset:192 nt
  buffer_load_dwordx4 v[144:147], v5, s[44:47], s57 offen offset:0 nt
  buffer_load_dwordx4 v[148:151], v5, s[44:47], s57 offen offset:256 nt
  buffer_load_dwordx4 v[152:155], v5, s[44:47], s57 offen offset:512 nt
  buffer_load_dwordx4 v[156:159], v5, s[44:47], s57 offen offset:768 nt
  s_add_u32 s57, s57, 32768
  buffer_load_dwordx4 v[160:163], v4, s[40:43], s57 offen offset:0 nt
  buffer_load_dwordx4 v[164:167], v4, s[40:43], s57 offen offset:64 nt
  buffer_load_dwordx4 v[168:171], v4, s[40:43], s57 offen offset:128 nt
  buffer_load_dwordx4 v[172:175], v4, s[40:43], s57 offen offset:192 nt
  buffer_load_dwordx4 v[176:179], v5, s[44:47], s57 offen offset:0 nt
  buffer_load_dwordx4 v[180:183], v5, s[44:47], s57 offen offset:256 nt
  buffer_load_dwordx4 v[184:187], v5, s[44:47], s57 offen offset:512 nt
  buffer_load_dwordx4 v[188:191], v5, s[44:47], s57 offen offset:768 nt
  s_add_u32 s57, s57, 32768
  v_lshrrev_b32 v3, 3, v0
  v_and_b32 v11, 7, v0
  v_lshlrev_b32 v11, 4, v11
  v_lshl_add_u32 v202, v3, 10, v11
  s_lshl_b32 s64, s52, 17
  s_lshl_b32 s65, s53, 7
  s_add_u32 s64, s64, s65
  v_add_u32 v202, s64, v202
  v_min_u32 v3, 42, v3
  v_lshl_add_u32 v203, v3, 10, v11
  s_mul_i32 s64, s52, 44032
  s_add_u32 s64, s64, s65
  v_add_u32 v203, s64, v203
  v_mov_b32 v8, 0xff800000
  v_mov_b32 v9, 0
  v_mov_b32 v10, 0
  v_mov_b32 v12, 0
  v_mov_b32 v13, 0
  v_mov_b32 v14, 0
  v_mov_b32 v15, 0
  v_mov_b32 v16, 0
  v_mov_b32 v17, 0
  v_mov_b32 v18, 0
  v_mov_b32 v19, 0
  s_mov_b32 s58, 0
  s_add_u32 s74, s38, 786432
  s_addc_u32 s75, s39, 0
  s_waitcnt lgkmcnt(0)
  s_waitcnt vmcnt(28)
  s_waitcnt lgkmcnt(0)
  v_readfirstlane_b32 s80, v240
  s_add_u32 s58, s58, 1
  s_lshr_b32 s64, s80, 3
  s_mul_i32 s57, s64, 131072
  s_and_b32 s64, s80, 7
  s_lshl_b32 s64, s64, 12
  s_add_u32 s57, s57, s64
  s_lshl_b32 s64, s53, 20
  s_add_u32 s57, s57, s64
  s_cmp_ge_u32 s54, 8
  s_cbranch_scc1 L_noclaim0
  s_mov_b64 exec, 1
  ds_add_rtn_u32 v240, v241, v242 offset:4112
  s_mov_b64 exec, -1
  s_branch L_claimed0
L_noclaim0:
  v_mov_b32 v240, 0xffff
L_claimed0:
  v_mfma_f32_16x16x32_bf16 v[20:23], v[64:67], v[208:211], 0
  v_mfma_f32_16x16x32_bf16 v[20:23], v[68:71], v[212:215], v[20:23]
  v_mfma_f32_16x16x32_bf16 v[20:23], v[72:75], v[216:219], v[20:23]
  v_mfma_f32_16x16x32_bf16 v[20:23], v[76:79], v[220:223], v[20:23]
  buffer_load_dwordx4 v[64:67], v4, s[40:43], s57 offen offset:0 nt
  buffer_load_dwordx4 v[68:71], v4, s[40:43], s57 offen offset:64 nt
  buffer_load_dwordx4 v[72:75], v4, s[40:43], s57 offen offset:128 nt
  buffer_load_dwordx4 v[76:79], v4, s[40:43], s57 offen offset:192 nt
  s_nop 4
  v_cvt_pk_bf16_f32 v24, v20, v21
  v_cvt_pk_bf16_f32 v25, v22, v23
  v_lshlrev_b32 v20, 16, v24
  v_and_b32 v21, s59, v24
  v_lshlrev_b32 v22, 16, v25
  v_and_b32 v23, s59, v25
  v_mul_f32 v20, s60, v20
  v_mul_f32 v21, s60, v21
  v_mul_f32 v22, s60, v22
  v_mul_f32 v23, s60, v23
  v_cvt_pk_bf16_f32 v24, v20, v21
  v_cvt_pk_bf16_f32 v25, v22, v23
  v_lshlrev_b32 v20, 16, v24
  v_and_b32 v21, s59, v24
  v_lshlrev_b32 v22, 16, v25
  v_and_b32 v23, s59, v25
  v_max3_f32 v24, v20, v21, v22
  v_max3_f32 v24, v24, v23, v8
  v_cmp_gt_f32 vcc, v24, v8
  s_cbranch_vccz L_nors1
  v_sub_f32 v25, v8, v24
  v_mul_f32 v25, s61, v25
  v_exp_f32 v25, v25
  v_mov_b32 v8, v24
  v_mul_f32 v10, s61, v24
  v_sub_f32 v10, 0, v10
  v_mul_f32 v9, v9, v25
  v_mul_f32 v12, v12, v25
  v_mul_f32 v13, v13, v25
  v_mul_f32 v14, v14, v25
  v_mul_f32 v15, v15, v25
  v_mul_f32 v16, v16, v25
  v_mul_f32 v17, v17, v25
  v_mul_f32 v18, v18, v25
  v_mul_f32 v19, v19, v25
L_nors1:
  v_fma_f32 v20, v20, s61, v10
  v_fma_f32 v21, v21, s61, v10
  v_fma_f32 v22, v22, s61, v10
  v_fma_f32 v23, v23, s61, v10
  v_exp_f32 v20, v20
  v_exp_f32 v21, v21
  v_exp_f32 v22, v22
  v_exp_f32 v23, v23
  v_cvt_pk_bf16_f32 v6, v20, v21
  v_cvt_pk_bf16_f32 v7, v22, v23
  v_add_f32 v24, v20, v21
  v_add_f32 v25, v22, v23
  v_add_f32 v9, v9, v24
  s_waitcnt vmcnt(28)
  v_add_f32 v9, v9, v25
  v_perm_b32 v24, v84, v80, s6
  v_perm_b32 v25, v84, v80, s7
  v_perm_b32 v26, v85, v81, s6
  v_perm_b32 v27, v85, v81, s7
  v_perm_b32 v28, v86, v82, s6
  v_perm_b32 v29, v86, v82, s7
  v_perm_b32 v30, v87, v83, s6
  v_perm_b32 v31, v87, v83, s7
  v_dot2_f32_bf16 v12, v24, v6, v12
  v_dot2_f32_bf16 v13, v25, v6, v13
  v_dot2_f32_bf16 v14, v26, v6, v14
  v_dot2_f32_bf16 v15, v27, v6, v15
  v_dot2_f32_bf16 v16, v28, v6, v16
  v_dot2_f32_bf16 v17, v29, v6, v17
  v_dot2_f32_bf16 v18, v30, v6, v18
  v_dot2_f32_bf16 v19, v31, v6, v19
  v_perm_b32 v24, v92, v88, s6
  v_perm_b32 v25, v92, v88, s7
  v_perm_b32 v26, v93, v89, s6
  v_perm_b32 v27, v93, v89, s7
  v_perm_b32 v28, v94, v90, s6
  v_perm_b32 v29, v94, v90, s7
  v_perm_b32 v30, v95, v91, s6
  v_perm_b32 v31, v95, v91, s7
  v_dot2_f32_bf16 v12, v24, v7, v12
  v_dot2_f32_bf16 v13, v25, v7, v13
  v_dot2_f32_bf16 v14, v26, v7, v14
  v_dot2_f32_bf16 v15, v27, v7, v15
  v_dot2_f32_bf16 v16, v28, v7, v16
  v_dot2_f32_bf16 v17, v29, v7, v17
  v_dot2_f32_bf16 v18, v30, v7, v18
  v_dot2_f32_bf16 v19, v31, v7, v19
  buffer_load_dwordx4 v[80:83], v5, s[44:47], s57 offen offset:0 nt
  buffer_load_dwordx4 v[84:87], v5, s[44:47], s57 offen offset:256 nt
  buffer_load_dwordx4 v[88:91], v5, s[44:47], s57 offen offset:512 nt
  buffer_load_dwordx4 v[92:95], v5, s[44:47], s57 offen offset:768 nt
  s_add_u32 s57, s57, 32768
  s_waitcnt vmcnt(28)
  v_mfma_f32_16x16x32_bf16 v[20:23], v[96:99], v[208:211], 0
  v_mfma_f32_16x16x32_bf16 v[20:23], v[100:103], v[212:215], v[20:23]
  v_mfma_f32_16x16x32_bf16 v[20:23], v[104:107], v[216:219], v[20:23]
  v_mfma_f32_16x16x32_bf16 v[20:23], v[108:111], v[220:223], v[20:23]
  buffer_load_dwordx4 v[96:99], v4, s[40:43], s57 offen offset:0 nt
  buffer_load_dwordx4 v[100:103], v4, s[40:43], s57 offen offset:64 nt
  buffer_load_dwordx4 v[104:107], v4, s[40:43], s57 offen offset:128 nt
  buffer_load_dwordx4 v[108:111], v4, s[40:43], s57 offen offset:192 nt
  s_nop 4
  v_cvt_pk_bf16_f32 v24, v20, v21
  v_cvt_pk_bf16_f32 v25, v22, v23
  v_lshlrev_b32 v20, 16, v24
  v_and_b32 v21, s59, v24
  v_lshlrev_b32 v22, 16, v25
  v_and_b32 v23, s59, v25
  v_mul_f32 v20, s60, v20
  v_mul_f32 v21, s60, v21
  v_mul_f32 v22, s60, v22
  v_mul_f32 v23, s60, v23
  v_cvt_pk_bf16_f32 v24, v20, v21
  v_cvt_pk_bf16_f32 v25, v22, v23
  v_lshlrev_b32 v20, 16, v24
  v_and_b32 v21, s59, v24
  v_lshlrev_b32 v22, 16, v25
  v_and_b32 v23, s59, v25
  v_max3_f32 v24, v20, v21, v22
  v_max3_f32 v24, v24, v23, v8
  v_cmp_gt_f32 vcc, v24, v8
  s_cbranch_vccz L_nors2
  v_sub_f32 v25, v8, v24
  v_mul_f32 v25, s61, v25
  v_exp_f32 v25, v25
  v_mov_b32 v8, v24
  v_mul_f32 v10, s61, v24
  v_sub_f32 v10, 0, v10
  v_mul_f32 v9, v9, v25
  v_mul_f32 v12, v12, v25
  v_mul_f32 v13, v13, v25
  v_mul_f32 v14, v14, v25
  v_mul_f32 v15, v15, v25
  v_mul_f32 v16, v16, v25
  v_mul_f32 v17, v17, v25
  v_mul_f32 v18, v18, v25
  v_mul_f32 v19, v19, v25
L_nors2:
  v_fma_f32 v20, v20, s61, v10
  v_fma_f32 v21, v21, s61, v10
  v_fma_f32 v22, v22, s61, v10
  v_fma_f32 v23, v23, s61, v10
  v_exp_f32 v20, v20
  v_exp_f32 v21, v21
  v_exp_f32 v22, v22
  v_exp_f32 v23, v23
  v_cvt_pk_bf16_f32 v6, v20, v21
  v_cvt_pk_bf16_f32 v7, v22, v23
  v_add_f32 v24, v20, v21
  v_add_f32 v25, v22, v23
  v_add_f32 v9, v9, v24
  s_waitcnt vmcnt(28)
  v_add_f32 v9, v9, v25
  v_perm_b32 v24, v116, v112, s6
  v_perm_b32 v25, v116, v112, s7
  v_perm_b32 v26, v117, v113, s6
  v_perm_b32 v27, v117, v113, s7
  v_perm_b32 v28, v118, v114, s6
  v_perm_b32 v29, v118, v114, s7
  v_perm_b32 v30, v119, v115, s6
  v_perm_b32 v31, v119, v115, s7
  v_dot2_f32_bf16 v12, v24, v6, v12
  v_dot2_f32_bf16 v13, v25, v6, v13
  v_dot2_f32_bf16 v14, v26, v6, v14
  v_dot2_f32_bf16 v15, v27, v6, v15
  v_dot2_f32_bf16 v16, v28, v6, v16
  v_dot2_f32_bf16 v17, v29, v6, v17
  v_dot2_f32_bf16 v18, v30, v6, v18
  v_dot2_f32_bf16 v19, v31, v6, v19
  v_perm_b32 v24, v124, v120, s6
  v_perm_b32 v25, v124, v120, s7
  v_perm_b32 v26, v125, v121, s6
  v_perm_b32 v27, v125, v121, s7
  v_perm_b32 v28, v126, v122, s6
  v_perm_b32 v29, v126, v122, s7
  v_perm_b32 v30, v127, v123, s6
  v_perm_b32 v31, v127, v123, s7
  v_dot2_f32_bf16 v12, v24, v7, v12
  v_dot2_f32_bf16 v13, v25, v7, v13
  v_dot2_f32_bf16 v14, v26, v7, v14
  v_dot2_f32_bf16 v15, v27, v7, v15
  v_dot2_f32_bf16 v16, v28, v7, v16
  v_dot2_f32_bf16 v17, v29, v7, v17
  v_dot2_f32_bf16 v18, v30, v7, v18
  v_dot2_f32_bf16 v19, v31, v7, v19
  buffer_load_dwordx4 v[112:115], v5, s[44:47], s57 offen offset:0 nt
  buffer_load_dwordx4 v[116:119], v5, s[44:47], s57 offen offset:256 nt
  buffer_load_dwordx4 v[120:123], v5, s[44:47], s57 offen offset:512 nt
  buffer_load_dwordx4 v[124:127], v5, s[44:47], s57 offen offset:768 nt
  s_add_u32 s57, s57, 32768
  s_waitcnt vmcnt(28)
  v_mfma_f32_16x16x32_bf16 v[20:23], v[128:131], v[208:211], 0
  v_mfma_f32_16x16x32_bf16 v[20:23], v[132:135], v[212:215], v[20:23]
  v_mfma_f32_16x16x32_bf16 v[20:23], v[136:139], v[216:219], v[20:23]
  v_mfma_f32_16x16x32_bf16 v[20:23], v[140:143], v[220:223], v[20:23]
  buffer_load_dwordx4 v[128:131], v4, s[40:43], s57 offen offset:0 nt
  buffer_load_dwordx4 v[132:135], v4, s[40:43], s57 offen offset:64 nt
  buffer_load_dwordx4 v[136:139], v4, s[40:43], s57 offen offset:128 nt
  buffer_load_dwordx4 v[140:143], v4, s[40:43], s57 offen offset:192 nt
  s_nop 4
  v_cvt_pk_bf16_f32 v24, v20, v21
  v_cvt_pk_bf16_f32 v25, v22, v23
  v_lshlrev_b32 v20, 16, v24
  v_and_b32 v21, s59, v24
  v_lshlrev_b32 v22, 16, v25
  v_and_b32 v23, s59, v25
  v_mul_f32 v20, s60, v20
  v_mul_f32 v21, s60, v21
  v_mul_f32 v22, s60, v22
  v_mul_f32 v23, s60, v23
  v_cvt_pk_bf16_f32 v24, v20, v21
  v_cvt_pk_bf16_f32 v25, v22, v23
  v_lshlrev_b32 v20, 16, v24
  v_and_b32 v21, s59, v24
  v_lshlrev_b32 v22, 16, v25
  v_and_b32 v23, s59, v25
  v_max3_f32 v24, v20, v21, v22
  v_max3_f32 v24, v24, v23, v8
  v_cmp_gt_f32 vcc, v24, v8
  s_cbranch_vccz L_nors3
  v_sub_f32 v25, v8, v24
  v_mul_f32 v25, s61, v25
  v_exp_f32 v25, v25
  v_mov_b32 v8, v24
  v_mul_f32 v10, s61, v24
  v_sub_f32 v10, 0, v10
  v_mul_f32 v9, v9, v25
  v_mul_f32 v12, v12, v25
  v_mul_f32 v13, v13, v25
  v_mul_f32 v14, v14, v25
  v_mul_f32 v15, v15, v25
  v_mul_f32 v16, v16, v25
  v_mul_f32 v17, v17, v25
  v_mul_f32 v18, v18, v25
  v_mul_f32 v19, v19, v25
L_nors3:
  v_fma_f32 v20, v20, s61, v10
  v_fma_f32 v21, v21, s61, v10
  v_fma_f32 v22, v22, s61, v10
  v_fma_f32 v23, v23, s61, v10
  v_exp_f32 v20, v20
  v_exp_f32 v21, v21
  v_exp_f32 v22, v22
  v_exp_f32 v23, v23
  v_cvt_pk_bf16_f32 v6, v20, v21
  v_cvt_pk_bf16_f32 v7, v22, v23
  v_add_f32 v24, v20, v21
  v_add_f32 v25, v22, v23
  v_add_f32 v9, v9, v24
  s_waitcnt vmcnt(28)
  v_add_f32 v9, v9, v25
  v_perm_b32 v24, v148, v144, s6
  v_perm_b32 v25, v148, v144, s7
  v_perm_b32 v26, v149, v145, s6
  v_perm_b32 v27, v149, v145, s7
  v_perm_b32 v28, v150, v146, s6
  v_perm_b32 v29, v150, v146, s7
  v_perm_b32 v30, v151, v147, s6
  v_perm_b32 v31, v151, v147, s7
  v_dot2_f32_bf16 v12, v24, v6, v12
  v_dot2_f32_bf16 v13, v25, v6, v13
  v_dot2_f32_bf16 v14, v26, v6, v14
  v_dot2_f32_bf16 v15, v27, v6, v15
  v_dot2_f32_bf16 v16, v28, v6, v16
  v_dot2_f32_bf16 v17, v29, v6, v17
  v_dot2_f32_bf16 v18, v30, v6, v18
  v_dot2_f32_bf16 v19, v31, v6, v19
  v_perm_b32 v24, v156, v152, s6
  v_perm_b32 v25, v156, v152, s7
  v_perm_b32 v26, v157, v153, s6
  v_perm_b32 v27, v157, v153, s7
  v_perm_b32 v28, v158, v154, s6
  v_perm_b32 v29, v158, v154, s7
  v_perm_b32 v30, v159, v155, s6
  v_perm_b32 v31, v159, v155, s7
  v_dot2_f32_bf16 v12, v24, v7, v12
  v_dot2_f32_bf16 v13, v25, v7, v13
  v_dot2_f32_bf16 v14, v26, v7, v14
  v_dot2_f32_bf16 v15, v27, v7, v15
  v_dot2_f32_bf16 v16, v28, v7, v16
  v_dot2_f32_bf16 v17, v29, v7, v17
  v_dot2_f32_bf16 v18, v30, v7, v18
  v_dot2_f32_bf16 v19, v31, v7, v19
  buffer_load_dwordx4 v[144:147], v5, s[44:47], s57 offen offset:0 nt
  buffer_load_dwordx4 v[148:151], v5, s[44:47], s57 offen offset:256 nt
  buffer_load_dwordx4 v[152:155], v5, s[44:47], s57 offen offset:512 nt
  buffer_load_dwordx4 v[156:159], v5, s[44:47], s57 offen offset:768 nt
  s_add_u32 s57, s57, 32768
  s_waitcnt vmcnt(28)
  v_mfma_f32_16x16x32_bf16 v[20:23], v[160:163], v[208:211], 0
  v_mfma_f32_16x16x32_bf16 v[20:23], v[164:167], v[212:215], v[20:23]
  v_mfma_f32_16x16x32_bf16 v[20:23], v[168:171], v[216:219], v[20:23]
  v_mfma_f32_16x16x32_bf16 v[20:23], v[172:175], v[220:223], v[20:23]
  buffer_load_dwordx4 v[160:163], v4, s[40:43], s57 offen offset:0 nt
  buffer_load_dwordx4 v[164:167], v4, s[40:43], s57 offen offset:64 nt
  buffer_load_dwordx4 v[168:171], v4, s[40:43], s57 offen offset:128 nt
  buffer_load_dwordx4 v[172:175], v4, s[40:43], s57 offen offset:192 nt
  s_nop 4
  v_cvt_pk_bf16_f32 v24, v20, v21
  v_cvt_pk_bf16_f32 v25, v22, v23
  v_lshlrev_b32 v20, 16, v24
  v_and_b32 v21, s59, v24
  v_lshlrev_b32 v22, 16, v25
  v_and_b32 v23, s59, v25
  v_mul_f32 v20, s60, v20
  v_mul_f32 v21, s60, v21
  v_mul_f32 v22, s60, v22
  v_mul_f32 v23, s60, v23
  v_cvt_pk_bf16_f32 v24, v20, v21
  v_cvt_pk_bf16_f32 v25, v22, v23
  v_lshlrev_b32 v20, 16, v24
  v_and_b32 v21, s59, v24
  v_lshlrev_b32 v22, 16, v25
  v_and_b32 v23, s59, v25
  v_max3_f32 v24, v20, v21, v22
  v_max3_f32 v24, v24, v23, v8
  v_cmp_gt_f32 vcc, v24, v8
  s_cbranch_vccz L_nors4
  v_sub_f32 v25, v8, v24
  v_mul_f32 v25, s61, v25
  v_exp_f32 v25, v25
  v_mov_b32 v8, v24
  v_mul_f32 v10, s61, v24
  v_sub_f32 v10, 0, v10
  v_mul_f32 v9, v9, v25
  v_mul_f32 v12, v12, v25
  v_mul_f32 v13, v13, v25
  v_mul_f32 v14, v14, v25
  v_mul_f32 v15, v15, v25
  v_mul_f32 v16, v16, v25
  v_mul_f32 v17, v17, v25
  v_mul_f32 v18, v18, v25
  v_mul_f32 v19, v19, v25
L_nors4:
  v_fma_f32 v20, v20, s61, v10
  v_fma_f32 v21, v21, s61, v10
  v_fma_f32 v22, v22, s61, v10
  v_fma_f32 v23, v23, s61, v10
  v_exp_f32 v20, v20
  v_exp_f32 v21, v21
  v_exp_f32 v22, v22
  v_exp_f32 v23, v23
  v_cvt_pk_bf16_f32 v6, v20, v21
  v_cvt_pk_bf16_f32 v7, v22, v23
  v_add_f32 v24, v20, v21
  v_add_f32 v25, v22, v23
  v_add_f32 v9, v9, v24
  s_waitcnt vmcnt(28)
  v_add_f32 v9, v9, v25
  v_perm_b32 v24, v180, v176, s6
  v_perm_b32 v25, v180, v176, s7
  v_perm_b32 v26, v181, v177, s6
  v_perm_b32 v27, v181, v177, s7
  v_perm_b32 v28, v182, v178, s6
  v_perm_b32 v29, v182, v178, s7
  v_perm_b32 v30, v183, v179, s6
  v_perm_b32 v31, v183, v179, s7
  v_dot2_f32_bf16 v12, v24, v6, v12
  v_dot2_f32_bf16 v13, v25, v6, v13
  v_dot2_f32_bf16 v14, v26, v6, v14
  v_dot2_f32_bf16 v15, v27, v6, v15
  v_dot2_f32_bf16 v16, v28, v6, v16
  v_dot2_f32_bf16 v17, v29, v6, v17
  v_dot2_f32_bf16 v18, v30, v6, v18
  v_dot2_f32_bf16 v19, v31, v6, v19
  v_perm_b32 v24, v188, v184, s6
  v_perm_b32 v25, v188, v184, s7
  v_perm_b32 v26, v189, v185, s6
  v_perm_b32 v27, v189, v185, s7
  v_perm_b32 v28, v190, v186, s6
  v_perm_b32 v29, v190, v186, s7
  v_perm_b32 v30, v191, v187, s6
  v_perm_b32 v31, v191, v187, s7
  v_dot2_f32_bf16 v12, v24, v7, v12
  v_dot2_f32_bf16 v13, v25, v7, v13
  v_dot2_f32_bf16 v14, v26, v7, v14
  v_dot2_f32_bf16 v15, v27, v7, v15
  v_dot2_f32_bf16 v16, v28, v7, v16
  v_dot2_f32_bf16 v17, v29, v7, v17
  v_dot2_f32_bf16 v18, v30, v7, v18
  v_dot2_f32_bf16 v19, v31, v7, v19
  buffer_load_dwordx4 v[176:179], v5, s[44:47], s57 offen offset:0 nt
  buffer_load_dwordx4 v[180:183], v5, s[44:47], s57 offen offset:256 nt
  buffer_load_dwordx4 v[184:187], v5, s[44:47], s57 offen offset:512 nt
  buffer_load_dwordx4 v[188:191], v5, s[44:47], s57 offen offset:768 nt
  s_add_u32 s57, s57, 32768
L_loop:
  s_waitcnt vmcnt(28)
  s_waitcnt lgkmcnt(0)
  v_readfirstlane_b32 s80, v240
  s_cmp_eq_u32 s58, 1
  s_cbranch_scc1 L_p1
L_p1_ret:
  s_add_u32 s58, s58, 1
  s_cmp_ge_u32 s80, 64
  s_cbranch_scc1 L_drain
  s_lshr_b32 s64, s80, 3
  s_mul_i32 s57, s64, 131072
  s_and_b32 s64, s80, 7
  s_lshl_b32 s64, s64, 12
  s_add_u32 s57, s57, s64
  s_lshl_b32 s64, s53, 20
  s_add_u32 s57, s57, s64
  s_cmp_ge_u32 s54, 8
  s_cbranch_scc1 L_noclaim5
  s_mov_b64 exec, 1
  ds_add_rtn_u32 v240, v241, v242 offset:4112
  s_mov_b64 exec, -1
  s_branch L_claimed5
L_noclaim5:
  v_mov_b32 v240, 0xffff
L_claimed5:
  v_mfma_f32_16x16x32_bf16 v[20:23], v[64:67], v[208:211], 0
  v_mfma_f32_16x16x32_bf16 v[20:23], v[68:71], v[212:215], v[20:23]
  v_mfma_f32_16x16x32_bf16 v[20:23], v[72:75], v[216:219], v[20:23]
  v_mfma_f32_16x16x32_bf16 v[20:23], v[76:79], v[220:223], v[20:23]
  buffer_load_dwordx4 v[64:67], v4, s[40:43], s57 offen offset:0 nt
  buffer_load_dwordx4 v[68:71], v4, s[40:43], s57 offen offset:64 nt
  buffer_load_dwordx4 v[72:75], v4, s[40:43], s57 offen offset:128 nt
  buffer_load_dwordx4 v[76:79], v4, s[40:43], s57 offen offset:192 nt
  s_nop 4
  v_cvt_pk_bf16_f32 v24, v20, v21
  v_cvt_pk_bf16_f32 v25, v22, v23
  v_lshlrev_b32 v20, 16, v24
  v_and_b32 v21, s59, v24
  v_lshlrev_b32 v22, 16, v25
  v_and_b32 v23, s59, v25
  v_mul_f32 v20, s60, v20
  v_mul_f32 v21, s60, v21
  v_mul_f32 v22, s60, v22
  v_mul_f32 v23, s60, v23
  v_cvt_pk_bf16_f32 v24, v20, v21
  v_cvt_pk_bf16_f32 v25, v22, v23
  v_lshlrev_b32 v20, 16, v24
  v_and_b32 v21, s59, v24
  v_lshlrev_b32 v22, 16, v25
  v_and_b32 v23, s59, v25
  v_max3_f32 v24, v20, v21, v22
  v_max3_f32 v24, v24, v23, v8
  v_cmp_gt_f32 vcc, v24, v8
  s_cbranch_vccz L_nors6
  v_sub_f32 v25, v8, v24
  v_mul_f32 v25, s61, v25
  v_exp_f32 v25, v25
  v_mov_b32 v8, v24
  v_mul_f32 v10, s61, v24
  v_sub_f32 v10, 0, v10
  v_mul_f32 v9, v9, v25
  v_mul_f32 v12, v12, v25
  v_mul_f32 v13, v13, v25
  v_mul_f32 v14, v14, v25
  v_mul_f32 v15, v15, v25
  v_mul_f32 v16, v16, v25
  v_mul_f32 v17, v17, v25
  v_mul_f32 v18, v18, v25
  v_mul_f32 v19, v19, v25
L_nors6:
  v_fma_f32 v20, v20, s61, v10
  v_fma_f32 v21, v21, s61, v10
  v_fma_f32 v22, v22, s61, v10
  v_fma_f32 v23, v23, s61, v10
  v_exp_f32 v20, v20
  v_exp_f32 v21, v21
  v_exp_f32 v22, v22
  v_exp_f32 v23, v23
  v_cvt_pk_bf16_f32 v6, v20, v21
  v_cvt_pk_bf16_f32 v7, v22, v23
  v_add_f32 v24, v20, v21
  v_add_f32 v25, v22, v23
  v_add_f32 v9, v9, v24
  s_waitcnt vmcnt(28)
  v_add_f32 v9, v9, v25
  v_perm_b32 v24, v84, v80, s6
  v_perm_b32 v25, v84, v80, s7
  v_perm_b32 v26, v85, v81, s6
  v_perm_b32 v27, v85, v81, s7
  v_perm_b32 v28, v86, v82, s6
  v_perm_b32 v29, v86, v82, s7
  v_perm_b32 v30, v87, v83, s6
  v_perm_b32 v31, v87, v83, s7
  v_dot2_f32_bf16 v12, v24, v6, v12
  v_dot2_f32_bf16 v13, v25, v6, v13
  v_dot2_f32_bf16 v14, v26, v6, v14
  v_dot2_f32_bf16 v15, v27, v6, v15
  v_dot2_f32_bf16 v16, v28, v6, v16
  v_dot2_f32_bf16 v17, v29, v6, v17
  v_dot2_f32_bf16 v18, v30, v6, v18
  v_dot2_f32_bf16 v19, v31, v6, v19
  v_perm_b32 v24, v92, v88, s6
  v_perm_b32 v25, v92, v88, s7
  v_perm_b32 v26, v93, v89, s6
  v_perm_b32 v27, v93, v89, s7
  v_perm_b32 v28, v94, v90, s6
  v_perm_b32 v29, v94, v90, s7
  v_perm_b32 v30, v95, v91, s6
  v_perm_b32 v31, v95, v91, s7
  v_dot2_f32_bf16 v12, v24, v7, v12
  v_dot2_f32_bf16 v13, v25, v7, v13
  v_dot2_f32_bf16 v14, v26, v7, v14
  v_dot2_f32_bf16 v15, v27, v7, v15
  v_dot2_f32_bf16 v16, v28, v7, v16
  v_dot2_f32_bf16 v17, v29, v7, v17
  v_dot2_f32_bf16 v18, v30, v7, v18
  v_dot2_f32_bf16 v19, v31, v7, v19
  buffer_load_dwordx4 v[80:83], v5, s[44:47], s57 offen offset:0 nt
  buffer_load_dwordx4 v[84:87], v5, s[44:47], s57 offen offset:256 nt
  buffer_load_dwordx4 v[88:91], v5, s[44:47], s57 offen offset:512 nt
  buffer_load_dwordx4 v[92:95], v5, s[44:47], s57 offen offset:768 nt
  s_add_u32 s57, s57, 32768
  s_waitcnt vmcnt(28)
  v_mfma_f32_16x16x32_bf16 v[20:23], v[96:99], v[208:211], 0
  v_mfma_f32_16x16x32_bf16 v[20:23], v[100:103], v[212:215], v[20:23]
  v_mfma_f32_16x16x32_bf16 v[20:23], v[104:107], v[216:219], v[20:23]
  v_mfma_f32_16x16x32_bf16 v[20:23], v[108:111], v[220:223], v[20:23]
  buffer_load_dwordx4 v[96:99], v4, s[40:43], s57 offen offset:0 nt
  buffer_load_dwordx4 v[100:103], v4, s[40:43], s57 offen offset:64 nt
  buffer_load_dwordx4 v[104:107], v4, s[40:43], s57 offen offset:128 nt
  buffer_load_dwordx4 v[108:111], v4, s[40:43], s57 offen offset:192 nt
  s_nop 4
  v_cvt_pk_bf16_f32 v24, v20, v21
  v_cvt_pk_bf16_f32 v25, v22, v23
  v_lshlrev_b32 v20, 16, v24
  v_and_b32 v21, s59, v24
  v_lshlrev_b32 v22, 16, v25
  v_and_b32 v23, s59, v25
  v_mul_f32 v20, s60, v20
  v_mul_f32 v21, s60, v21
  v_mul_f32 v22, s60, v22
  v_mul_f32 v23, s60, v23
  v_cvt_pk_bf16_f32 v24, v20, v21
  v_cvt_pk_bf16_f32 v25, v22, v23
  v_lshlrev_b32 v20, 16, v24
  v_and_b32 v21, s59, v24
  v_lshlrev_b32 v22, 16, v25
  v_and_b32 v23, s59, v25
  v_max3_f32 v24, v20, v21, v22
  v_max3_f32 v24, v24, v23, v8
  v_cmp_gt_f32 vcc, v24, v8
  s_cbranch_vccz L_nors7
  v_sub_f32 v25, v8, v24
  v_mul_f32 v25, s61, v25
  v_exp_f32 v25, v25
  v_mov_b32 v8, v24
  v_mul_f32 v10, s61, v24
  v_sub_f32 v10, 0, v10
  v_mul_f32 v9, v9, v25
  v_mul_f32 v12, v12, v25
  v_mul_f32 v13, v13, v25
  v_mul_f32 v14, v14, v25
  v_mul_f32 v15, v15, v25
  v_mul_f32 v16, v16, v25
  v_mul_f32 v17, v17, v25
  v_mul_f32 v18, v18, v25
  v_mul_f32 v19, v19, v25
L_nors7:
  v_fma_f32 v20, v20, s61, v10
  v_fma_f32 v21, v21, s61, v10
  v_fma_f32 v22, v22, s61, v10
  v_fma_f32 v23, v23, s61, v10
  v_exp_f32 v20, v20
  v_exp_f32 v21, v21
  v_exp_f32 v22, v22
  v_exp_f32 v23, v23
  v_cvt_pk_bf16_f32 v6, v20, v21
  v_cvt_pk_bf16_f32 v7, v22, v23
  v_add_f32 v24, v20, v21
  v_add_f32 v25, v22, v23
  v_add_f32 v9, v9, v24
  s_waitcnt vmcnt(28)
  v_add_f32 v9, v9, v25
  v_perm_b32 v24, v116, v112, s6
  v_perm_b32 v25, v116, v112, s7
  v_perm_b32 v26, v117, v113, s6
  v_perm_b32 v27, v117, v113, s7
  v_perm_b32 v28, v118, v114, s6
  v_perm_b32 v29, v118, v114, s7
  v_perm_b32 v30, v119, v115, s6
  v_perm_b32 v31, v119, v115, s7
  v_dot2_f32_bf16 v12, v24, v6, v12
  v_dot2_f32_bf16 v13, v25, v6, v13
  v_dot2_f32_bf16 v14, v26, v6, v14
  v_dot2_f32_bf16 v15, v27, v6, v15
  v_dot2_f32_bf16 v16, v28, v6, v16
  v_dot2_f32_bf16 v17, v29, v6, v17
  v_dot2_f32_bf16 v18, v30, v6, v18
  v_dot2_f32_bf16 v19, v31, v6, v19
  v_perm_b32 v24, v124, v120, s6
  v_perm_b32 v25, v124, v120, s7
  v_perm_b32 v26, v125, v121, s6
  v_perm_b32 v27, v125, v121, s7
  v_perm_b32 v28, v126, v122, s6
  v_perm_b32 v29, v126, v122, s7
  v_perm_b32 v30, v127, v123, s6
  v_perm_b32 v31, v127, v123, s7
  v_dot2_f32_bf16 v12, v24, v7, v12
  v_dot2_f32_bf16 v13, v25, v7, v13
  v_dot2_f32_bf16 v14, v26, v7, v14
  v_dot2_f32_bf16 v15, v27, v7, v15
  v_dot2_f32_bf16 v16, v28, v7, v16
  v_dot2_f32_bf16 v17, v29, v7, v17
  v_dot2_f32_bf16 v18, v30, v7, v18
  v_dot2_f32_bf16 v19, v31, v7, v19
  buffer_load_dwordx4 v[112:115], v5, s[44:47], s57 offen offset:0 nt
  buffer_load_dwordx4 v[116:119], v5, s[44:47], s57 offen offset:256 nt
  buffer_load_dwordx4 v[120:123], v5, s[44:47], s57 offen offset:512 nt
  buffer_load_dwordx4 v[124:127], v5, s[44:47], s57 offen offset:768 nt
  s_add_u32 s57, s57, 32768
  s_waitcnt vmcnt(28)
  v_mfma_f32_16x16x32_bf16 v[20:23], v[128:131], v[208:211], 0
  v_mfma_f32_16x16x32_bf16 v[20:23], v[132:135], v[212:215], v[20:23]
  v_mfma_f32_16x16x32_bf16 v[20:23], v[136:139], v[216:219], v[20:23]
  v_mfma_f32_16x16x32_bf16 v[20:23], v[140:143], v[220:223], v[20:23]
  buffer_load_dwordx4 v[128:131], v4, s[40:43], s57 offen offset:0 nt
  buffer_load_dwordx4 v[132:135], v4, s[40:43], s57 offen offset:64 nt
  buffer_load_dwordx4 v[136:139], v4, s[40:43], s57 offen offset:128 nt
  buffer_load_dwordx4 v[140:143], v4, s[40:43], s57 offen offset:192 nt
  s_nop 4
  v_cvt_pk_bf16_f32 v24, v20, v21
  v_cvt_pk_bf16_f32 v25, v22, v23
  v_lshlrev_b32 v20, 16, v24
  v_and_b32 v21, s59, v24
  v_lshlrev_b32 v22, 16, v25
  v_and_b32 v23, s59, v25
  v_mul_f32 v20, s60, v20
  v_mul_f32 v21, s60, v21
  v_mul_f32 v22, s60, v22
  v_mul_f32 v23, s60, v23
  v_cvt_pk_bf16_f32 v24, v20, v21
  v_cvt_pk_bf16_f32 v25, v22, v23
  v_lshlrev_b32 v20, 16, v24
  v_and_b32 v21, s59, v24
  v_lshlrev_b32 v22, 16, v25
  v_and_b32 v23, s59, v25
  v_max3_f32 v24, v20, v21, v22
  v_max3_f32 v24, v24, v23, v8
  v_cmp_gt_f32 vcc, v24, v8
  s_cbranch_vccz L_nors8
  v_sub_f32 v25, v8, v24
  v_mul_f32 v25, s61, v25
  v_exp_f32 v25, v25
  v_mov_b32 v8, v24
  v_mul_f32 v10, s61, v24
  v_sub_f32 v10, 0, v10
  v_mul_f32 v9, v9, v25
  v_mul_f32 v12, v12, v25
  v_mul_f32 v13, v13, v25
  v_mul_f32 v14, v14, v25
  v_mul_f32 v15, v15, v25
  v_mul_f32 v16, v16, v25
  v_mul_f32 v17, v17, v25
  v_mul_f32 v18, v18, v25
  v_mul_f32 v19, v19, v25
L_nors8:
  v_fma_f32 v20, v20, s61, v10
  v_fma_f32 v21, v21, s61, v10
  v_fma_f32 v22, v22, s61, v10
  v_fma_f32 v23, v23, s61, v10
  v_exp_f32 v20, v20
  v_exp_f32 v21, v21
  v_exp_f32 v22, v22
  v_exp_f32 v23, v23
  v_cvt_pk_bf16_f32 v6, v20, v21
  v_cvt_pk_bf16_f32 v7, v22, v23
  v_add_f32 v24, v20, v21
  v_add_f32 v25, v22, v23
  v_add_f32 v9, v9, v24
  s_waitcnt vmcnt(28)
  v_add_f32 v9, v9, v25
  v_perm_b32 v24, v148, v144, s6
  v_perm_b32 v25, v148, v144, s7
  v_perm_b32 v26, v149, v145, s6
  v_perm_b32 v27, v149, v145, s7
  v_perm_b32 v28, v150, v146, s6
  v_perm_b32 v29, v150, v146, s7
  v_perm_b32 v30, v151, v147, s6
  v_perm_b32 v31, v151, v147, s7
  v_dot2_f32_bf16 v12, v24, v6, v12
  v_dot2_f32_bf16 v13, v25, v6, v13
  v_dot2_f32_bf16 v14, v26, v6, v14
  v_dot2_f32_bf16 v15, v27, v6, v15
  v_dot2_f32_bf16 v16, v28, v6, v16
  v_dot2_f32_bf16 v17, v29, v6, v17
  v_dot2_f32_bf16 v18, v30, v6, v18
  v_dot2_f32_bf16 v19, v31, v6, v19
  v_perm_b32 v24, v156, v152, s6
  v_perm_b32 v25, v156, v152, s7
  v_perm_b32 v26, v157, v153, s6
  v_perm_b32 v27, v157, v153, s7
  v_perm_b32 v28, v158, v154, s6
  v_perm_b32 v29, v158, v154, s7
  v_perm_b32 v30, v159, v155, s6
  v_perm_b32 v31, v159, v155, s7
  v_dot2_f32_bf16 v12, v24, v7, v12
  v_dot2_f32_bf16 v13, v25, v7, v13
  v_dot2_f32_bf16 v14, v26, v7, v14
  v_dot2_f32_bf16 v15, v27, v7, v15
  v_dot2_f32_bf16 v16, v28, v7, v16
  v_dot2_f32_bf16 v17, v29, v7, v17
  v_dot2_f32_bf16 v18, v30, v7, v18
  v_dot2_f32_bf16 v19, v31, v7, v19
  buffer_load_dwordx4 v[144:147], v5, s[44:47], s57 offen offset:0 nt
  buffer_load_dwordx4 v[148:151], v5, s[44:47], s57 offen offset:256 nt
  buffer_load_dwordx4 v[152:155], v5, s[44:47], s57 offen offset:512 nt
  buffer_load_dwordx4 v[156:159], v5, s[44:47], s57 offen offset:768 nt
  s_add_u32 s57, s57, 32768
  s_waitcnt vmcnt(28)
  v_mfma_f32_16x16x32_bf16 v[20:23], v[160:163], v[208:211], 0
  v_mfma_f32_16x16x32_bf16 v[20:23], v[164:167], v[212:215], v[20:23]
  v_mfma_f32_16x16x32_bf16 v[20:23], v[168:171], v[216:219], v[20:23]
  v_mfma_f32_16x16x32_bf16 v[20:23], v[172:175], v[220:223], v[20:23]
  buffer_load_dwordx4 v[160:163], v4, s[40:43], s57 offen offset:0 nt
  buffer_load_dwordx4 v[164:167], v4, s[40:43], s57 offen offset:64 nt
  buffer_load_dwordx4 v[168:171], v4, s[40:43], s57 offen offset:128 nt
  buffer_load_dwordx4 v[172:175], v4, s[40:43], s57 offen offset:192 nt
  s_nop 4
  v_cvt_pk_bf16_f32 v24, v20, v21
  v_cvt_pk_bf16_f32 v25, v22, v23
  v_lshlrev_b32 v20, 16, v24
  v_and_b32 v21, s59, v24
  v_lshlrev_b32 v22, 16, v25
  v_and_b32 v23, s59, v25
  v_mul_f32 v20, s60, v20
  v_mul_f32 v21, s60, v21
  v_mul_f32 v22, s60, v22
  v_mul_f32 v23, s60, v23
  v_cvt_pk_bf16_f32 v24, v20, v21
  v_cvt_pk_bf16_f32 v25, v22, v23
  v_lshlrev_b32 v20, 16, v24
  v_and_b32 v21, s59, v24
  v_lshlrev_b32 v22, 16, v25
  v_and_b32 v23, s59, v25
  v_max3_f32 v24, v20, v21, v22
  v_max3_f32 v24, v24, v23, v8
  v_cmp_gt_f32 vcc, v24, v8
  s_cbranch_vccz L_nors9
  v_sub_f32 v25, v8, v24
  v_mul_f32 v25, s61, v25
  v_exp_f32 v25, v25
  v_mov_b32 v8, v24
  v_mul_f32 v10, s61, v24
  v_sub_f32 v10, 0, v10
  v_mul_f32 v9, v9, v25
  v_mul_f32 v12, v12, v25
  v_mul_f32 v13, v13, v25
  v_mul_f32 v14, v14, v25
  v_mul_f32 v15, v15, v25
  v_mul_f32 v16, v16, v25
  v_mul_f32 v17, v17, v25
  v_mul_f32 v18, v18, v25
  v_mul_f32 v19, v19, v25
L_nors9:
  v_fma_f32 v20, v20, s61, v10
  v_fma_f32 v21, v21, s61, v10
  v_fma_f32 v22, v22, s61, v10
  v_fma_f32 v23, v23, s61, v10
  v_exp_f32 v20, v20
  v_exp_f32 v21, v21
  v_exp_f32 v22, v22
  v_exp_f32 v23, v23
  v_cvt_pk_bf16_f32 v6, v20, v21
  v_cvt_pk_bf16_f32 v7, v22, v23
  v_add_f32 v24, v20, v21
  v_add_f32 v25, v22, v23
  v_add_f32 v9, v9, v24
  s_waitcnt vmcnt(28)
  v_add_f32 v9, v9, v25
  v_perm_b32 v24, v180, v176, s6
  v_perm_b32 v25, v180, v176, s7
  v_perm_b32 v26, v181, v177, s6
  v_perm_b32 v27, v181, v177, s7
  v_perm_b32 v28, v182, v178, s6
  v_perm_b32 v29, v182, v178, s7
  v_perm_b32 v30, v183, v179, s6
  v_perm_b32 v31, v183, v179, s7
  v_dot2_f32_bf16 v12, v24, v6, v12
  v_dot2_f32_bf16 v13, v25, v6, v13
  v_dot2_f32_bf16 v14, v26, v6, v14
  v_dot2_f32_bf16 v15, v27, v6, v15
  v_dot2_f32_bf16 v16, v28, v6, v16
  v_dot2_f32_bf16 v17, v29, v6, v17
  v_dot2_f32_bf16 v18, v30, v6, v18
  v_dot2_f32_bf16 v19, v31, v6, v19
  v_perm_b32 v24, v188, v184, s6
  v_perm_b32 v25, v188, v184, s7
  v_perm_b32 v26, v189, v185, s6
  v_perm_b32 v27, v189, v185, s7
  v_perm_b32 v28, v190, v186, s6
  v_perm_b32 v29, v190, v186, s7
  v_perm_b32 v30, v191, v187, s6
  v_perm_b32 v31, v191, v187, s7
  v_dot2_f32_bf16 v12, v24, v7, v12
  v_dot2_f32_bf16 v13, v25, v7, v13
  v_dot2_f32_bf16 v14, v26, v7, v14
  v_dot2_f32_bf16 v15, v27, v7, v15
  v_dot2_f32_bf16 v16, v28, v7, v16
  v_dot2_f32_bf16 v17, v29, v7, v17
  v_dot2_f32_bf16 v18, v30, v7, v18
  v_dot2_f32_bf16 v19, v31, v7, v19
  buffer_load_dwordx4 v[176:179], v5, s[44:47], s57 offen offset:0 nt
  buffer_load_dwordx4 v[180:183], v5, s[44:47], s57 offen offset:256 nt
  buffer_load_dwordx4 v[184:187], v5, s[44:47], s57 offen offset:512 nt
  buffer_load_dwordx4 v[188:191], v5, s[44:47], s57 offen offset:768 nt
  s_add_u32 s57, s57, 32768
  s_branch L_loop
L_drain:
  s_waitcnt vmcnt(28)
  v_mfma_f32_16x16x32_bf16 v[20:23], v[64:67], v[208:211], 0
  v_mfma_f32_16x16x32_bf16 v[20:23], v[68:71], v[212:215], v[20:23]
  v_mfma_f32_16x16x32_bf16 v[20:23], v[72:75], v[216:219], v[20:23]
  v_mfma_f32_16x16x32_bf16 v[20:23], v[76:79], v[220:223], v[20:23]
  s_nop 8
  v_cvt_pk_bf16_f32 v24, v20, v21
  v_cvt_pk_bf16_f32 v25, v22, v23
  v_lshlrev_b32 v20, 16, v24
  v_and_b32 v21, s59, v24
  v_lshlrev_b32 v22, 16, v25
  v_and_b32 v23, s59, v25
  v_mul_f32 v20, s60, v20
  v_mul_f32 v21, s60, v21
  v_mul_f32 v22, s60, v22
  v_mul_f32 v23, s60, v23
  v_cvt_pk_bf16_f32 v24, v20, v21
  v_cvt_pk_bf16_f32 v25, v22, v23
  v_lshlrev_b32 v20, 16, v24
  v_and_b32 v21, s59, v24
  v_lshlrev_b32 v22, 16, v25
  v_and_b32 v23, s59, v25
  v_max3_f32 v24, v20, v21, v22
  v_max3_f32 v24, v24, v23, v8
  v_cmp_gt_f32 vcc, v24, v8
  s_cbranch_vccz L_nors10
  v_sub_f32 v25, v8, v24
  v_mul_f32 v25, s61, v25
  v_exp_f32 v25, v25
  v_mov_b32 v8, v24
  v_mul_f32 v10, s61, v24
  v_sub_f32 v10, 0, v10
  v_mul_f32 v9, v9, v25
  v_mul_f32 v12, v12, v25
  v_mul_f32 v13, v13, v25
  v_mul_f32 v14, v14, v25
  v_mul_f32 v15, v15, v25
  v_mul_f32 v16, v16, v25
  v_mul_f32 v17, v17, v25
  v_mul_f32 v18, v18, v25
  v_mul_f32 v19, v19, v25
L_nors10:
  v_fma_f32 v20, v20, s61, v10
  v_fma_f32 v21, v21, s61, v10
  v_fma_f32 v22, v22, s61, v10
  v_fma_f32 v23, v23, s61, v10
  v_exp_f32 v20, v20
  v_exp_f32 v21, v21
  v_exp_f32 v22, v22
  v_exp_f32 v23, v23
  v_cvt_pk_bf16_f32 v6, v20, v21
  v_cvt_pk_bf16_f32 v7, v22, v23
  v_add_f32 v24, v20, v21
  v_add_f32 v25, v22, v23
  v_add_f32 v9, v9, v24
  s_waitcnt vmcnt(24)
  v_add_f32 v9, v9, v25
  v_perm_b32 v24, v84, v80, s6
  v_perm_b32 v25, v84, v80, s7
  v_perm_b32 v26, v85, v81, s6
  v_perm_b32 v27, v85, v81, s7
  v_perm_b32 v28, v86, v82, s6
  v_perm_b32 v29, v86, v82, s7
  v_perm_b32 v30, v87, v83, s6
  v_perm_b32 v31, v87, v83, s7
  v_dot2_f32_bf16 v12, v24, v6, v12
  v_dot2_f32_bf16 v13, v25, v6, v13
  v_dot2_f32_bf16 v14, v26, v6, v14
  v_dot2_f32_bf16 v15, v27, v6, v15
  v_dot2_f32_bf16 v16, v28, v6, v16
  v_dot2_f32_bf16 v17, v29, v6, v17
  v_dot2_f32_bf16 v18, v30, v6, v18
  v_dot2_f32_bf16 v19, v31, v6, v19
  v_perm_b32 v24, v92, v88, s6
  v_perm_b32 v25, v92, v88, s7
  v_perm_b32 v26, v93, v89, s6
  v_perm_b32 v27, v93, v89, s7
  v_perm_b32 v28, v94, v90, s6
  v_perm_b32 v29, v94, v90, s7
  v_perm_b32 v30, v95, v91, s6
  v_perm_b32 v31, v95, v91, s7
  v_dot2_f32_bf16 v12, v24, v7, v12
  v_dot2_f32_bf16 v13, v25, v7, v13
  v_dot2_f32_bf16 v14, v26, v7, v14
  v_dot2_f32_bf16 v15, v27, v7, v15
  v_dot2_f32_bf16 v16, v28, v7, v16
  v_dot2_f32_bf16 v17, v29, v7, v17
  v_dot2_f32_bf16 v18, v30, v7, v18
  v_dot2_f32_bf16 v19, v31, v7, v19
  s_waitcnt vmcnt(20)
  v_mfma_f32_16x16x32_bf16 v[20:23], v[96:99], v[208:211], 0
  v_mfma_f32_16x16x32_bf16 v[20:23], v[100:103], v[212:215], v[20:23]
  v_mfma_f32_16x16x32_bf16 v[20:23], v[104:107], v[216:219], v[20:23]
  v_mfma_f32_16x16x32_bf16 v[20:23], v[108:111], v[220:223], v[20:23]
  s_nop 8
  v_cvt_pk_bf16_f32 v24, v20, v21
  v_cvt_pk_bf16_f32 v25, v22, v23
  v_lshlrev_b32 v20, 16, v24
  v_and_b32 v21, s59, v24
  v_lshlrev_b32 v22, 16, v25
  v_and_b32 v23, s59, v25
  v_mul_f32 v20, s60, v20
  v_mul_f32 v21, s60, v21
  v_mul_f32 v22, s60, v22
  v_mul_f32 v23, s60, v23
  v_cvt_pk_bf16_f32 v24, v20, v21
  v_cvt_pk_bf16_f32 v25, v22, v23
  v_lshlrev_b32 v20, 16, v24
  v_and_b32 v21, s59, v24
  v_lshlrev_b32 v22, 16, v25
  v_and_b32 v23, s59, v25
  v_max3_f32 v24, v20, v21, v22
  v_max3_f32 v24, v24, v23, v8
  v_cmp_gt_f32 vcc, v24, v8
  s_cbranch_vccz L_nors11
  v_sub_f32 v25, v8, v24
  v_mul_f32 v25, s61, v25
  v_exp_f32 v25, v25
  v_mov_b32 v8, v24
  v_mul_f32 v10, s61, v24
  v_sub_f32 v10, 0, v10
  v_mul_f32 v9, v9, v25
  v_mul_f32 v12, v12, v25
  v_mul_f32 v13, v13, v25
  v_mul_f32 v14, v14, v25
  v_mul_f32 v15, v15, v25
  v_mul_f32 v16, v16, v25
  v_mul_f32 v17, v17, v25
  v_mul_f32 v18, v18, v25
  v_mul_f32 v19, v19, v25
L_nors11:
  v_fma_f32 v20, v20, s61, v10
  v_fma_f32 v21, v21, s61, v10
  v_fma_f32 v22, v22, s61, v10
  v_fma_f32 v23, v23, s61, v10
  v_exp_f32 v20, v20
  v_exp_f32 v21, v21
  v_exp_f32 v22, v22
  v_exp_f32 v23, v23
  v_cvt_pk_bf16_f32 v6, v20, v21
  v_cvt_pk_bf16_f32 v7, v22, v23
  v_add_f32 v24, v20, v21
  v_add_f32 v25, v22, v23
  v_add_f32 v9, v9, v24
  s_waitcnt vmcnt(16)
  v_add_f32 v9, v9, v25
  v_perm_b32 v24, v116, v112, s6
  v_perm_b32 v25, v116, v112, s7
  v_perm_b32 v26, v117, v113, s6
  v_perm_b32 v27, v117, v113, s7
  v_perm_b32 v28, v118, v114, s6
  v_perm_b32 v29, v118, v114, s7
  v_perm_b32 v30, v119, v115, s6
  v_perm_b32 v31, v119, v115, s7
  v_dot2_f32_bf16 v12, v24, v6, v12
  v_dot2_f32_bf16 v13, v25, v6, v13
  v_dot2_f32_bf16 v14, v26, v6, v14
  v_dot2_f32_bf16 v15, v27, v6, v15
  v_dot2_f32_bf16 v16, v28, v6, v16
  v_dot2_f32_bf16 v17, v29, v6, v17
  v_dot2_f32_bf16 v18, v30, v6, v18
  v_dot2_f32_bf16 v19, v31, v6, v19
  v_perm_b32 v24, v124, v120, s6
  v_perm_b32 v25, v124, v120, s7
  v_perm_b32 v26, v125, v121, s6
  v_perm_b32 v27, v125, v121, s7
  v_perm_b32 v28, v126, v122, s6
  v_perm_b32 v29, v126, v122, s7
  v_perm_b32 v30, v127, v123, s6
  v_perm_b32 v31, v127, v123, s7
  v_dot2_f32_bf16 v12, v24, v7, v12
  v_dot2_f32_bf16 v13, v25, v7, v13
  v_dot2_f32_bf16 v14, v26, v7, v14
  v_dot2_f32_bf16 v15, v27, v7, v15
  v_dot2_f32_bf16 v16, v28, v7, v16
  v_dot2_f32_bf16 v17, v29, v7, v17
  v_dot2_f32_bf16 v18, v30, v7, v18
  v_dot2_f32_bf16 v19, v31, v7, v19
  s_waitcnt vmcnt(12)
  v_mfma_f32_16x16x32_bf16 v[20:23], v[128:131], v[208:211], 0
  v_mfma_f32_16x16x32_bf16 v[20:23], v[132:135], v[212:215], v[20:23]
  v_mfma_f32_16x16x32_bf16 v[20:23], v[136:139], v[216:219], v[20:23]
  v_mfma_f32_16x16x32_bf16 v[20:23], v[140:143], v[220:223], v[20:23]
  s_nop 8
  v_cvt_pk_bf16_f32 v24, v20, v21
  v_cvt_pk_bf16_f32 v25, v22, v23
  v_lshlrev_b32 v20, 16, v24
  v_and_b32 v21, s59, v24
  v_lshlrev_b32 v22, 16, v25
  v_and_b32 v23, s59, v25
  v_mul_f32 v20, s60, v20
  v_mul_f32 v21, s60, v21
  v_mul_f32 v22, s60, v22
  v_mul_f32 v23, s60, v23
  v_cvt_pk_bf16_f32 v24, v20, v21
  v_cvt_pk_bf16_f32 v25, v22, v23
  v_lshlrev_b32 v20, 16, v24
  v_and_b32 v21, s59, v24
  v_lshlrev_b32 v22, 16, v25
  v_and_b32 v23, s59, v25
  v_max3_f32 v24, v20, v21, v22
  v_max3_f32 v24, v24, v23, v8
  v_cmp_gt_f32 vcc, v24, v8
  s_cbranch_vccz L_nors12
  v_sub_f32 v25, v8, v24
  v_mul_f32 v25, s61, v25
  v_exp_f32 v25, v25
  v_mov_b32 v8, v24
  v_mul_f32 v10, s61, v24
  v_sub_f32 v10, 0, v10
  v_mul_f32 v9, v9, v25
  v_mul_f32 v12, v12, v25
  v_mul_f32 v13, v13, v25
  v_mul_f32 v14, v14, v25
  v_mul_f32 v15, v15, v25
  v_mul_f32 v16, v16, v25
  v_mul_f32 v17, v17, v25
  v_mul_f32 v18, v18, v25
  v_mul_f32 v19, v19, v25
L_nors12:
  v_fma_f32 v20, v20, s61, v10
  v_fma_f32 v21, v21, s61, v10
  v_fma_f32 v22, v22, s61, v10
  v_fma_f32 v23, v23, s61, v10
  v_exp_f32 v20, v20
  v_exp_f32 v21, v21
  v_exp_f32 v22, v22
  v_exp_f32 v23, v23
  v_cvt_pk_bf16_f32 v6, v20, v21
  v_cvt_pk_bf16_f32 v7, v22, v23
  v_add_f32 v24, v20, v21
  v_add_f32 v25, v22, v23
  v_add_f32 v9, v9, v24
  s_waitcnt vmcnt(8)
  v_add_f32 v9, v9, v25
  v_perm_b32 v24, v148, v144, s6
  v_perm_b32 v25, v148, v144, s7
  v_perm_b32 v26, v149, v145, s6
  v_perm_b32 v27, v149, v145, s7
  v_perm_b32 v28, v150, v146, s6
  v_perm_b32 v29, v150, v146, s7
  v_perm_b32 v30, v151, v147, s6
  v_perm_b32 v31, v151, v147, s7
  v_dot2_f32_bf16 v12, v24, v6, v12
  v_dot2_f32_bf16 v13, v25, v6, v13
  v_dot2_f32_bf16 v14, v26, v6, v14
  v_dot2_f32_bf16 v15, v27, v6, v15
  v_dot2_f32_bf16 v16, v28, v6, v16
  v_dot2_f32_bf16 v17, v29, v6, v17
  v_dot2_f32_bf16 v18, v30, v6, v18
  v_dot2_f32_bf16 v19, v31, v6, v19
  v_perm_b32 v24, v156, v152, s6
  v_perm_b32 v25, v156, v152, s7
  v_perm_b32 v26, v157, v153, s6
  v_perm_b32 v27, v157, v153, s7
  v_perm_b32 v28, v158, v154, s6
  v_perm_b32 v29, v158, v154, s7
  v_perm_b32 v30, v159, v155, s6
  v_perm_b32 v31, v159, v155, s7
  v_dot2_f32_bf16 v12, v24, v7, v12
  v_dot2_f32_bf16 v13, v25, v7, v13
  v_dot2_f32_bf16 v14, v26, v7, v14
  v_dot2_f32_bf16 v15, v27, v7, v15
  v_dot2_f32_bf16 v16, v28, v7, v16
  v_dot2_f32_bf16 v17, v29, v7, v17
  v_dot2_f32_bf16 v18, v30, v7, v18
  v_dot2_f32_bf16 v19, v31, v7, v19
  s_waitcnt vmcnt(4)
  v_mfma_f32_16x16x32_bf16 v[20:23], v[160:163], v[208:211], 0
  v_mfma_f32_16x16x32_bf16 v[20:23], v[164:167], v[212:215], v[20:23]
  v_mfma_f32_16x16x32_bf16 v[20:23], v[168:171], v[216:219], v[20:23]
  v_mfma_f32_16x16x32_bf16 v[20:23], v[172:175], v[220:223], v[20:23]
  s_nop 8
  v_cvt_pk_bf16_f32 v24, v20, v21
  v_cvt_pk_bf16_f32 v25, v22, v23
  v_lshlrev_b32 v20, 16, v24
  v_and_b32 v21, s59, v24
  v_lshlrev_b32 v22, 16, v25
  v_and_b32 v23, s59, v25
  v_mul_f32 v20, s60, v20
  v_mul_f32 v21, s60, v21
  v_mul_f32 v22, s60, v22
  v_mul_f32 v23, s60, v23
  v_cvt_pk_bf16_f32 v24, v20, v21
  v_cvt_pk_bf16_f32 v25, v22, v23
  v_lshlrev_b32 v20, 16, v24
  v_and_b32 v21, s59, v24
  v_lshlrev_b32 v22, 16, v25
  v_and_b32 v23, s59, v25
  v_max3_f32 v24, v20, v21, v22
  v_max3_f32 v24, v24, v23, v8
  v_cmp_gt_f32 vcc, v24, v8
  s_cbranch_vccz L_nors13
  v_sub_f32 v25, v8, v24
  v_mul_f32 v25, s61, v25
  v_exp_f32 v25, v25
  v_mov_b32 v8, v24
  v_mul_f32 v10, s61, v24
  v_sub_f32 v10, 0, v10
  v_mul_f32 v9, v9, v25
  v_mul_f32 v12, v12, v25
  v_mul_f32 v13, v13, v25
  v_mul_f32 v14, v14, v25
  v_mul_f32 v15, v15, v25
  v_mul_f32 v16, v16, v25
  v_mul_f32 v17, v17, v25
  v_mul_f32 v18, v18, v25
  v_mul_f32 v19, v19, v25
L_nors13:
  v_fma_f32 v20, v20, s61, v10
  v_fma_f32 v21, v21, s61, v10
  v_fma_f32 v22, v22, s61, v10
  v_fma_f32 v23, v23, s61, v10
  v_exp_f32 v20, v20
  v_exp_f32 v21, v21
  v_exp_f32 v22, v22
  v_exp_f32 v23, v23
  v_cvt_pk_bf16_f32 v6, v20, v21
  v_cvt_pk_bf16_f32 v7, v22, v23
  v_add_f32 v24, v20, v21
  v_add_f32 v25, v22, v23
  v_add_f32 v9, v9, v24
  s_waitcnt vmcnt(0)
  v_add_f32 v9, v9, v25
  v_perm_b32 v24, v180, v176, s6
  v_perm_b32 v25, v180, v176, s7
  v_perm_b32 v26, v181, v177, s6
  v_perm_b32 v27, v181, v177, s7
  v_perm_b32 v28, v182, v178, s6
  v_perm_b32 v29, v182, v178, s7
  v_perm_b32 v30, v183, v179, s6
  v_perm_b32 v31, v183, v179, s7
  v_dot2_f32_bf16 v12, v24, v6, v12
  v_dot2_f32_bf16 v13, v25, v6, v13
  v_dot2_f32_bf16 v14, v26, v6, v14
  v_dot2_f32_bf16 v15, v27, v6, v15
  v_dot2_f32_bf16 v16, v28, v6, v16
  v_dot2_f32_bf16 v17, v29, v6, v17
  v_dot2_f32_bf16 v18, v30, v6, v18
  v_dot2_f32_bf16 v19, v31, v6, v19
  v_perm_b32 v24, v188, v184, s6
  v_perm_b32 v25, v188, v184, s7
  v_perm_b32 v26, v189, v185, s6
  v_perm_b32 v27, v189, v185, s7
  v_perm_b32 v28, v190, v186, s6
  v_perm_b32 v29, v190, v186, s7
  v_perm_b32 v30, v191, v187, s6
  v_perm_b32 v31, v191, v187, s7
  v_dot2_f32_bf16 v12, v24, v7, v12
  v_dot2_f32_bf16 v13, v25, v7, v13
  v_dot2_f32_bf16 v14, v26, v7, v14
  v_dot2_f32_bf16 v15, v27, v7, v15
  v_dot2_f32_bf16 v16, v28, v7, v16
  v_dot2_f32_bf16 v17, v29, v7, v17
  v_dot2_f32_bf16 v18, v30, v7, v18
  v_dot2_f32_bf16 v19, v31, v7, v19
  s_cmp_lg_u32 s54, 7
  s_cbranch_scc1 L_noh
  s_mov_b32 s76, 0
L_h_chk:
  v_subrev_u32 v24, s81, v225
  v_subrev_u32 v25, s81, v227
  v_subrev_u32 v26, s81, v229
  v_subrev_u32 v27, s81, v231
  v_subrev_u32 v28, s81, v233
  v_subrev_u32 v29, s81, v235
  v_subrev_u32 v30, s81, v237
  v_subrev_u32 v31, s81, v239
  v_max3_u32 v24, v24, v25, v26
  v_max3_u32 v24, v24, v27, v28
  v_max3_u32 v24, v24, v29, v30
  v_max_u32 v24, v24, v31
  v_cmp_lt_u32 vcc, 2, v24
  s_cbranch_vccz L_h_ok
  s_add_u32 s76, s76, 1
  s_cmp_gt_u32 s76, 20000
  s_cbranch_scc1 L_h_ok
  v_min_u32 v3, 42, v2
  s_mul_i32 s64, s52, 43
  v_add_u32 v3, s64, v3
  v_lshlrev_b32 v3, 6, v3
  global_load_dwordx4 v[224:227], v3, s[74:75] offset:0 sc0 sc1
  global_load_dwordx4 v[228:231], v3, s[74:75] offset:16 sc0 sc1
  global_load_dwordx4 v[232:235], v3, s[74:75] offset:32 sc0 sc1
  global_load_dwordx4 v[236:239], v3, s[74:75] offset:48 sc0 sc1
  s_waitcnt vmcnt(0)
  s_branch L_h_chk
L_h_ok:
  v_add_f32 v24, v224, v226
  v_add_f32 v25, v232, v234
  v_add_f32 v24, v24, v228
  v_add_f32 v25, v25, v236
  v_add_f32 v24, v24, v230
  v_add_f32 v25, v25, v238
  v_cvt_pk_bf16_f32 v26, v24, v25
  v_lshlrev_b32 v24, 16, v26
  v_and_b32 v25, s59, v26
  v_mul_f32 v26, v24, v24
  v_mov_b32 v27, 0x3d372713
  v_mul_f32 v26, v26, v24
  v_fma_f32 v26, v26, v27, v24
  v_mul_f32 v26, 0x3f4c422a, v26
  v_mul_f32 v26, 0x4038aa3b, v26
  v_exp_f32 v26, v26
  s_nop 0
  v_add_f32 v26, 1.0, v26
  v_rcp_f32 v26, v26
  s_nop 0
  v_fma_f32 v26, v26, -2.0, 1.0
  v_add_f32 v26, 1.0, v26
  v_mul_f32 v27, 0.5, v24
  v_mul_f32 v26, v27, v26
  v_cvt_pk_bf16_f32 v27, v26, v26
  v_lshlrev_b32 v26, 16, v27
  v_mul_f32 v26, v26, v25
  v_cvt_pk_bf16_f32 v27, v26, v26
  v_lshlrev_b32 v26, 16, v27
  v_cmp_gt_u32 vcc, 43, v2
  v_lshlrev_b32 v3, 2, v2
  s_nop 0
  v_cndmask_b32 v26, 0, v26, vcc
  ds_write_b32 v3, v26 offset:4608
L_noh:
  v_readlane_b32 s62, v8, 0
  v_readlane_b32 s63, v8, 16
  v_readlane_b32 s64, v8, 32
  v_readlane_b32 s65, v8, 48
  s_nop 1
  v_mov_b32 v24, s62
  v_max_f32 v24, s63, v24
  v_max_f32 v24, s64, v24
  v_max_f32 v24, s65, v24
  v_sub_f32 v25, v8, v24
  v_mul_f32 v25, s61, v25
  v_exp_f32 v25, v25
  s_nop 0
  v_mul_f32 v9, v9, v25
  v_mul_f32 v12, v12, v25
  v_mul_f32 v13, v13, v25
  v_mul_f32 v14, v14, v25
  v_mul_f32 v15, v15, v25
  v_mul_f32 v16, v16, v25
  v_mul_f32 v17, v17, v25
  v_mul_f32 v18, v18, v25
  v_mul_f32 v19, v19, v25
  v_readlane_b32 s62, v9, 0
  v_readlane_b32 s63, v9, 16
  v_readlane_b32 s64, v9, 32
  v_readlane_b32 s65, v9, 48
  s_nop 1
  v_permlane32_swap_b32 v12, v16
  v_permlane32_swap_b32 v13, v17
  v_permlane32_swap_b32 v14, v18
  v_permlane32_swap_b32 v15, v19
  s_nop 0
  v_add_f32 v12, v12, v16
  v_add_f32 v13, v13, v17
  v_add_f32 v14, v14, v18
  v_add_f32 v15, v15, v19
  s_nop 1
  v_permlane16_swap_b32 v12, v14
  v_permlane16_swap_b32 v13, v15
  s_nop 0
  v_add_f32 v12, v12, v14
  v_add_f32 v13, v13, v15
  v_mov_b32 v25, s62
  v_add_f32 v25, s63, v25
  v_add_f32 v25, s64, v25
  v_add_f32 v25, s65, v25
  v_and_b32 v3, 15, v2
  v_lshlrev_b32 v3, 5, v3
  v_lshrrev_b32 v11, 4, v2
  v_lshl_add_u32 v3, v11, 3, v3
  s_lshl_b32 s64, s54, 9
  v_add_u32 v3, s64, v3
  ds_write_b64 v3, v[12:13] offset:8192
  s_lshl_b32 s64, s54, 3
  v_mov_b32 v11, s64
  ds_write_b64 v11, v[24:25] offset:12288
  s_waitcnt lgkmcnt(0)
  s_barrier
  s_cmp_lg_u32 s54, 0
  s_cbranch_scc1 L_nopub
  v_lshlrev_b32 v3, 3, v2
  ds_read_b64 v[80:81], v241 offset:12288
  ds_read_b64 v[82:83], v241 offset:12296
  ds_read_b64 v[84:85], v241 offset:12304
  ds_read_b64 v[86:87], v241 offset:12312
  ds_read_b64 v[88:89], v241 offset:12320
  ds_read_b64 v[90:91], v241 offset:12328
  ds_read_b64 v[92:93], v241 offset:12336
  ds_read_b64 v[94:95], v241 offset:12344
  ds_read_b64 v[64:65], v3 offset:8192
  ds_read_b64 v[66:67], v3 offset:8704
  ds_read_b64 v[68:69], v3 offset:9216
  ds_read_b64 v[70:71], v3 offset:9728
  ds_read_b64 v[72:73], v3 offset:10240
  ds_read_b64 v[74:75], v3 offset:10752
  ds_read_b64 v[76:77], v3 offset:11264
  ds_read_b64 v[78:79], v3 offset:11776
  s_waitcnt lgkmcnt(8)
  v_max3_f32 v28, v80, v82, v84
  v_max3_f32 v28, v28, v86, v88
  v_max3_f32 v28, v28, v90, v92
  v_max_f32 v28, v28, v94
  v_sub_f32 v80, v80, v28
  v_sub_f32 v82, v82, v28
  v_sub_f32 v84, v84, v28
  v_sub_f32 v86, v86, v28
  v_sub_f32 v88, v88, v28
  v_sub_f32 v90, v90, v28
  v_sub_f32 v92, v92, v28
  v_sub_f32 v94, v94, v28
  v_mul_f32 v80, s61, v80
  v_mul_f32 v82, s61, v82
  v_mul_f32 v84, s61, v84
  v_mul_f32 v86, s61, v86
  v_mul_f32 v88, s61, v88
  v_mul_f32 v90, s61, v90
  v_mul_f32 v92, s61, v92
  v_mul_f32 v94, s61, v94
  v_exp_f32 v80, v80
  v_exp_f32 v82, v82
  v_exp_f32 v84, v84
  v_exp_f32 v86, v86
  v_exp_f32 v88, v88
  v_exp_f32 v90, v90
  v_exp_f32 v92, v92
  v_exp_f32 v94, v94
  s_nop 0
  v_mul_f32 v30, v80, v81
  v_fmac_f32 v30, v82, v83
  v_fmac_f32 v30, v84, v85
  v_fmac_f32 v30, v86, v87
  v_fmac_f32 v30, v88, v89
  v_fmac_f32 v30, v90, v91
  v_fmac_f32 v30, v92, v93
  v_fmac_f32 v30, v94, v95
  s_waitcnt lgkmcnt(0)
  v_mul_f32 v24, v80, v64
  v_mul_f32 v26, v80, v65
  v_fmac_f32 v24, v82, v66
  v_fmac_f32 v26, v82, v67
  v_fmac_f32 v24, v84, v68
  v_fmac_f32 v26, v84, v69
  v_fmac_f32 v24, v86, v70
  v_fmac_f32 v26, v86, v71
  v_fmac_f32 v24, v88, v72
  v_fmac_f32 v26, v88, v73
  v_fmac_f32 v24, v90, v74
  v_fmac_f32 v26, v90, v75
  v_fmac_f32 v24, v92, v76
  v_fmac_f32 v26, v92, v77
  v_fmac_f32 v24, v94, v78
  v_fmac_f32 v26, v94, v79
  v_mov_b32 v25, s69
  v_mov_b32 v27, s69
  v_mov_b32 v29, s69
  v_mov_b32 v31, s69
  global_store_dwordx4 v1, v[24:27], s[70:71] sc0 sc1
  global_store_dwordx4 v241, v[28:31], s[70:71] offset:1024 sc0 sc1
L_nopub:
  s_lshl_b32 s64, s52, 3
  s_add_u32 s64, s64, s54
  s_lshl_b32 s64, s64, 11
  s_add_u32 s66, s38, s64
  s_addc_u32 s67, s39, 0
  global_load_dwordx4 v[64:67], v1, s[66:67] sc0 sc1
  global_load_dwordx4 v[68:71], v241, s[66:67] offset:1024 sc0 sc1
  v_lshrrev_b32 v3, 3, v0
  v_lshlrev_b32 v3, 2, v3
  ds_read_b32 v52, v3 offset:4608
  s_waitcnt lgkmcnt(0)
  v_lshlrev_b32 v32, 16, v48
  v_and_b32 v33, s59, v48
  v_mul_f32 v12, v52, v32
  v_mul_f32 v13, v52, v33
  v_lshlrev_b32 v32, 16, v49
  v_and_b32 v33, s59, v49
  v_mul_f32 v14, v52, v32
  v_mul_f32 v15, v52, v33
  v_lshlrev_b32 v32, 16, v50
  v_and_b32 v33, s59, v50
  v_mul_f32 v16, v52, v32
  v_mul_f32 v17, v52, v33
  v_lshlrev_b32 v32, 16, v51
  v_and_b32 v33, s59, v51
  v_mul_f32 v18, v52, v32
  v_mul_f32 v19, v52, v33
  s_nop 1
  v_permlane32_swap_b32 v12, v16
  v_permlane32_swap_b32 v13, v17
  v_permlane32_swap_b32 v14, v18
  v_permlane32_swap_b32 v15, v19
  s_nop 0
  v_add_f32 v12, v12, v16
  v_add_f32 v13, v13, v17
  v_add_f32 v14, v14, v18
  v_add_f32 v15, v15, v19
  s_nop 1
  v_permlane16_swap_b32 v12, v14
  v_permlane16_swap_b32 v13, v15
  s_nop 0
  v_add_f32 v12, v12, v14
  v_add_f32 v13, v13, v15
  s_nop 1
  v_add_f32_dpp v12, v12, v12 row_ror:8 row_mask:0xf bank_mask:0xf
  v_add_f32_dpp v13, v13, v13 row_ror:8 row_mask:0xf bank_mask:0xf
  v_and_b32 v3, 7, v2
  v_lshlrev_b32 v3, 5, v3
  v_lshrrev_b32 v11, 4, v2
  v_lshl_add_u32 v3, v11, 3, v3
  s_lshl_b32 s64, s54, 8
  v_add_u32 v3, s64, v3
  ds_write_b64 v3, v[12:13] offset:19200
  s_mov_b32 s76, 0
  s_branch L_poll1_chk
L_poll1:
  global_load_dwordx4 v[64:67], v1, s[66:67] sc0 sc1
  global_load_dwordx4 v[68:71], v241, s[66:67] offset:1024 sc0 sc1
L_poll1_chk:
  s_add_u32 s76, s76, 1
  s_cmp_gt_u32 s76, 20000
  s_cbranch_scc1 L_poll1_done
  s_waitcnt vmcnt(0)
  v_subrev_u32 v24, s81, v65
  v_subrev_u32 v25, s81, v67
  v_subrev_u32 v26, s81, v69
  v_subrev_u32 v27, s81, v71
  v_max3_u32 v24, v24, v25, v26
  v_max_u32 v24, v24, v27
  v_cmp_lt_u32 vcc, 2, v24
  s_cbranch_vccnz L_poll1
L_poll1_done:
  s_waitcnt vmcnt(0)
  v_mov_b32 v65, v66
  v_mov_b32 v69, v70
  v_lshlrev_b32 v3, 3, v2
  s_lshl_b32 s64, s54, 9
  v_add_u32 v3, s64, v3
  ds_write_b64 v3, v[64:65] offset:12800
  s_lshl_b32 s64, s54, 3
  v_mov_b32 v11, s64
  ds_write_b64 v11, v[68:69] offset:16896
  s_waitcnt lgkmcnt(0)
  s_barrier
  v_lshrrev_b32 v3, 3, v0
  v_lshlrev_b32 v3, 2, v3
  ds_read_b64 v[80:81], v241 offset:16896
  ds_read_b64 v[82:83], v241 offset:16904
  ds_read_b64 v[84:85], v241 offset:16912
  ds_read_b64 v[86:87], v241 offset:16920
  ds_read_b64 v[88:89], v241 offset:16928
  ds_read_b64 v[90:91], v241 offset:16936
  ds_read_b64 v[92:93], v241 offset:16944
  ds_read_b64 v[94:95], v241 offset:16952
  ds_read2st64_b32 v[64:65], v3 offset0:50 offset1:51
  ds_read2st64_b32 v[66:67], v3 offset0:52 offset1:53
  ds_read2st64_b32 v[68:69], v3 offset0:54 offset1:55
  ds_read2st64_b32 v[70:71], v3 offset0:56 offset1:57
  ds_read2st64_b32 v[72:73], v3 offset0:58 offset1:59
  ds_read2st64_b32 v[74:75], v3 offset0:60 offset1:61
  ds_read2st64_b32 v[76:77], v3 offset0:62 offset1:63
  ds_read2st64_b32 v[78:79], v3 offset0:64 offset1:65
  s_waitcnt lgkmcnt(8)
  v_max3_f32 v28, v80, v82, v84
  v_max3_f32 v28, v28, v86, v88
  v_max3_f32 v28, v28, v90, v92
  v_max_f32 v28, v28, v94
  v_sub_f32 v80, v80, v28
  v_sub_f32 v82, v82, v28
  v_sub_f32 v84, v84, v28
  v_sub_f32 v86, v86, v28
  v_sub_f32 v88, v88, v28
  v_sub_f32 v90, v90, v28
  v_sub_f32 v92, v92, v28
  v_sub_f32 v94, v94, v28
  v_mul_f32 v80, s61, v80
  v_mul_f32 v82, s61, v82
  v_mul_f32 v84, s61, v84
  v_mul_f32 v86, s61, v86
  v_mul_f32 v88, s61, v88
  v_mul_f32 v90, s61, v90
  v_mul_f32 v92, s61, v92
  v_mul_f32 v94, s61, v94
  v_exp_f32 v80, v80
  v_exp_f32 v82, v82
  v_exp_f32 v84, v84
  v_exp_f32 v86, v86
  v_exp_f32 v88, v88
  v_exp_f32 v90, v90
  v_exp_f32 v92, v92
  v_exp_f32 v94, v94
  s_nop 0
  v_mul_f32 v30, v80, v81
  v_fmac_f32 v30, v82, v83
  v_fmac_f32 v30, v84, v85
  v_fmac_f32 v30, v86, v87
  v_fmac_f32 v30, v88, v89
  v_fmac_f32 v30, v90, v91
  v_fmac_f32 v30, v92, v93
  v_fmac_f32 v30, v94, v95
  s_waitcnt lgkmcnt(0)
  v_mul_f32 v24, v80, v64
  v_mul_f32 v25, v80, v65
  v_fmac_f32 v24, v82, v66
  v_fmac_f32 v25, v82, v67
  v_fmac_f32 v24, v84, v68
  v_fmac_f32 v25, v84, v69
  v_fmac_f32 v24, v86, v70
  v_fmac_f32 v25, v86, v71
  v_fmac_f32 v24, v88, v72
  v_fmac_f32 v25, v88, v73
  v_fmac_f32 v24, v90, v74
  v_fmac_f32 v25, v90, v75
  v_fmac_f32 v24, v92, v76
  v_fmac_f32 v25, v92, v77
  v_fmac_f32 v24, v94, v78
  v_fmac_f32 v25, v94, v79
  v_rcp_f32 v31, v30
  s_nop 0
  v_mul_f32 v32, v24, v31
  v_fma_f32 v33, -v32, v30, v24
  v_fma_f32 v24, v33, v31, v32
  v_mul_f32 v32, v25, v31
  v_fma_f32 v33, -v32, v30, v25
  v_fma_f32 v25, v33, v31, v32
  v_cvt_pk_bf16_f32 v32, v24, v25
  v_lshlrev_b32 v24, 16, v32
  v_and_b32 v25, s59, v32
  v_lshlrev_b32 v32, 16, v40
  v_and_b32 v33, s59, v40
  v_mul_f32 v12, v24, v32
  v_mul_f32 v13, v24, v33
  v_lshlrev_b32 v32, 16, v41
  v_and_b32 v33, s59, v41
  v_mul_f32 v14, v24, v32
  v_mul_f32 v15, v24, v33
  v_lshlrev_b32 v32, 16, v42
  v_and_b32 v33, s59, v42
  v_mul_f32 v16, v24, v32
  v_mul_f32 v17, v24, v33
  v_lshlrev_b32 v32, 16, v43
  v_and_b32 v33, s59, v43
  v_mul_f32 v18, v24, v32
  v_mul_f32 v19, v24, v33
  v_lshlrev_b32 v32, 16, v44
  v_and_b32 v33, s59, v44
  v_fmac_f32 v12, v25, v32
  v_fmac_f32 v13, v25, v33
  v_lshlrev_b32 v32, 16, v45
  v_and_b32 v33, s59, v45
  v_fmac_f32 v14, v25, v32
  v_fmac_f32 v15, v25, v33
  v_lshlrev_b32 v32, 16, v46
  v_and_b32 v33, s59, v46
  v_fmac_f32 v16, v25, v32
  v_fmac_f32 v17, v25, v33
  v_lshlrev_b32 v32, 16, v47
  v_and_b32 v33, s59, v47
  v_fmac_f32 v18, v25, v32
  v_fmac_f32 v19, v25, v33
  s_nop 1
  v_permlane32_swap_b32 v12, v16
  v_permlane32_swap_b32 v13, v17
  v_permlane32_swap_b32 v14, v18
  v_permlane32_swap_b32 v15, v19
  s_nop 0
  v_add_f32 v12, v12, v16
  v_add_f32 v13, v13, v17
  v_add_f32 v14, v14, v18
  v_add_f32 v15, v15, v19
  s_nop 1
  v_permlane16_swap_b32 v12, v14
  v_permlane16_swap_b32 v13, v15
  s_nop 0
  v_add_f32 v12, v12, v14
  v_add_f32 v13, v13, v15
  s_nop 1
  v_add_f32_dpp v12, v12, v12 row_ror:8 row_mask:0xf bank_mask:0xf
  v_add_f32_dpp v13, v13, v13 row_ror:8 row_mask:0xf bank_mask:0xf
  v_and_b32 v3, 7, v2
  v_lshlrev_b32 v3, 5, v3
  v_lshrrev_b32 v11, 4, v2
  v_lshl_add_u32 v3, v11, 3, v3
  s_lshl_b32 s64, s54, 8
  v_add_u32 v3, s64, v3
  ds_write_b64 v3, v[12:13] offset:17152
  s_waitcnt lgkmcnt(0)
  s_barrier
  s_cmp_lg_u32 s54, 0
  s_cbranch_scc1 L_end
  v_lshlrev_b32 v3, 2, v2
  ds_read_b32 v64, v3 offset:17152
  ds_read_b32 v72, v3 offset:19200
  ds_read_b32 v65, v3 offset:17408
  ds_read_b32 v73, v3 offset:19456
  ds_read_b32 v66, v3 offset:17664
  ds_read_b32 v74, v3 offset:19712
  ds_read_b32 v67, v3 offset:17920
  ds_read_b32 v75, v3 offset:19968
  ds_read_b32 v68, v3 offset:18176
  ds_read_b32 v76, v3 offset:20224
  ds_read_b32 v69, v3 offset:18432
  ds_read_b32 v77, v3 offset:20480
  ds_read_b32 v70, v3 offset:18688
  ds_read_b32 v78, v3 offset:20736
  ds_read_b32 v71, v3 offset:18944
  ds_read_b32 v79, v3 offset:20992
  s_lshl_b32 s64, s53, 15
  s_add_u32 s64, s64, 524288
  s_lshl_b32 s65, s52, 5
  s_add_u32 s64, s64, s65
  s_add_u32 s66, s38, s64
  s_addc_u32 s67, s39, 0
  s_waitcnt lgkmcnt(0)
  v_add_f32 v64, v64, v65
  v_add_f32 v72, v72, v73
  v_add_f32 v64, v64, v66
  v_add_f32 v72, v72, v74
  v_add_f32 v64, v64, v67
  v_add_f32 v72, v72, v75
  v_add_f32 v64, v64, v68
  v_add_f32 v72, v72, v76
  v_add_f32 v64, v64, v69
  v_add_f32 v72, v72, v77
  v_add_f32 v64, v64, v70
  v_add_f32 v72, v72, v78
  v_add_f32 v64, v64, v71
  v_add_f32 v72, v72, v79
  v_mov_b32 v24, v64
  v_mov_b32 v25, s69
  v_mov_b32 v26, v72
  v_mov_b32 v27, s69
  global_store_dwordx4 v1, v[24:27], s[72:73] sc0 sc1
  v_and_b32 v3, 31, v2
  v_lshlrev_b32 v3, 10, v3
  v_lshrrev_b32 v11, 5, v2
  v_lshl_add_u32 v3, v11, 4, v3
  s_mov_b32 s76, 0
L_poll2:
  global_load_dwordx4 v[64:67], v3, s[66:67] sc0 sc1
  s_add_u32 s76, s76, 1
  s_cmp_gt_u32 s76, 20000
  s_cbranch_scc1 L_poll2_done
  s_waitcnt vmcnt(0)
  v_subrev_u32 v24, s81, v65
  v_subrev_u32 v25, s81, v67
  v_max_u32 v24, v24, v25
  v_cmp_lt_u32 vcc, 2, v24
  s_cbranch_vccnz L_poll2
L_poll2_done:
  s_waitcnt vmcnt(0)
  s_nop 0
  v_add_f32_dpp v64, v64, v64 quad_perm:[1,0,3,2] row_mask:0xf bank_mask:0xf
  v_add_f32_dpp v66, v66, v66 quad_perm:[1,0,3,2] row_mask:0xf bank_mask:0xf
  s_nop 0
  v_add_f32_dpp v64, v64, v64 quad_perm:[2,3,0,1] row_mask:0xf bank_mask:0xf
  v_add_f32_dpp v66, v66, v66 quad_perm:[2,3,0,1] row_mask:0xf bank_mask:0xf
  s_nop 0
  v_add_f32_dpp v64, v64, v64 row_half_mirror row_mask:0xf bank_mask:0xf
  v_add_f32_dpp v66, v66, v66 row_half_mirror row_mask:0xf bank_mask:0xf
  s_nop 0
  v_add_f32_dpp v64, v64, v64 row_mirror row_mask:0xf bank_mask:0xf
  v_add_f32_dpp v66, v66, v66 row_mirror row_mask:0xf bank_mask:0xf
  s_nop 0
  s_nop 0
  v_readlane_b32 s62, v64, 0
  v_readlane_b32 s63, v64, 16
  v_readlane_b32 s64, v64, 32
  v_readlane_b32 s65, v64, 48
  s_nop 1
  v_mov_b32 v24, s62
  v_add_f32 v24, s63, v24
  v_mov_b32 v25, s64
  v_add_f32 v25, s65, v25
  s_nop 1
  v_readlane_b32 s62, v66, 0
  v_readlane_b32 s63, v66, 16
  v_readlane_b32 s64, v66, 32
  v_readlane_b32 s65, v66, 48
  s_nop 1
  v_mov_b32 v26, s62
  v_add_f32 v26, s63, v26
  v_mov_b32 v27, s64
  v_add_f32 v27, s65, v27
  v_cvt_pk_bf16_f32 v32, v24, v25
  v_lshlrev_b32 v24, 16, v32
  v_and_b32 v25, s59, v32
  v_cvt_pk_bf16_f32 v32, v26, v27
  v_lshlrev_b32 v26, 16, v32
  v_and_b32 v27, s59, v32
  s_waitcnt lgkmcnt(0)
  s_lshl_b32 s62, s68, 16
  s_and_b32 s63, s68, s59
  v_add_f32 v24, s62, v24
  v_add_f32 v25, s63, v25
  v_cvt_pk_bf16_f32 v32, v24, v25
  v_lshlrev_b32 v24, 16, v32
  v_and_b32 v25, s59, v32
  v_add_f32 v24, v24, v26
  v_add_f32 v25, v25, v27
  v_cvt_pk_bf16_f32 v24, v24, v25
  s_lshl_b32 s64, s53, 7
  s_lshl_b32 s65, s52, 2
  s_add_u32 s64, s64, s65
  v_mov_b32 v3, s64
  v_cmp_eq_u32 vcc, 0, v2
  s_and_saveexec_b64 s[78:79], vcc
  global_store_dword v3, v24, s[34:35]
L_end:
  s_endpgm
L_p1:
  global_load_dwordx4 v[40:43], v202, s[24:25]
  v_add_u32 v202, 0x10000, v202
  global_load_dwordx4 v[44:47], v202, s[24:25]
  global_load_dwordx4 v[48:51], v203, s[32:33]
  s_cmp_lg_u32 s54, 7
  s_cbranch_scc1 L_p1_noh
  v_min_u32 v3, 42, v2
  s_mul_i32 s64, s52, 43
  v_add_u32 v3, s64, v3
  v_lshlrev_b32 v3, 6, v3
  global_load_dwordx4 v[224:227], v3, s[74:75] offset:0 sc0 sc1
  global_load_dwordx4 v[228:231], v3, s[74:75] offset:16 sc0 sc1
  global_load_dwordx4 v[232:235], v3, s[74:75] offset:32 sc0 sc1
  global_load_dwordx4 v[236:239], v3, s[74:75] offset:48 sc0 sc1
L_p1_noh:
  s_branch L_p1_ret
L_code_end:
.section .rodata,"a"
.p2align 6
.amdhsa_kernel parallel_sum__mha_block_cached__geglu_ffn__decode_kernel
  .amdhsa_next_free_vgpr 256
  .amdhsa_next_free_sgpr 96
  .amdhsa_accum_offset 256
  .amdhsa_group_segment_fixed_size 0
  .amdhsa_kernarg_size 96
  .amdhsa_user_sgpr_count 2
  .amdhsa_user_sgpr_kernarg_segment_ptr 1
  .amdhsa_system_sgpr_workgroup_id_x 1
.end_amdhsa_kernel
```
